```python
import torch

def _softmax(x, axis=-1):
    return torch.softmax(x, dim=axis)

def _gelu(x):
    return torch.nn.functional.gelu(x, approximate='tanh')

def _silu(x):
    return torch.nn.functional.silu(x)

def _sigmoid(x):
    return torch.sigmoid(x)

def _layernorm(x, axis=-1, eps=1e-05):
    m = x.mean(dim=axis, keepdim=True)
    v = x.var(dim=axis, keepdim=True, unbiased=False)
    return (x - m) / torch.sqrt(v + eps)

def _scatter_add(tgt, idx, src, axis=0):
    return tgt.clone().index_add_(axis, idx, src)

def _segment_sum(src, seg, n):
    out = torch.zeros((n,) + src.shape[1:], dtype=src.dtype)
    return out.index_add_(0, seg, src)

def _pad(x, pw):
    flat = tuple((v for pair in reversed(pw) for v in pair))
    return torch.nn.functional.pad(x, flat)
kernel_name = 'adaLN_cond__sliding_block_cached__glu_gated_glu__decode'

def setup_inputs():

    _w = lambda a: (lambda t: t.to(torch.bfloat16) if t.is_floating_point() else t)(torch.as_tensor(a))

    def _A_setup():
        B, Sq, D = (1, 1, 512)
        Hq, Hkv, Sk, Dh = (32, 8, 16384, 128)
        assert Hq % Hkv == 0, (Hq, Hkv)
        return {'x': _w((lambda *s: torch.randn(*s, dtype=torch.bfloat16) * 0.1)(B, Sq, D)), 'k_cache': _w((lambda *s: torch.randn(*s, dtype=torch.bfloat16) * 0.8)(B, Hkv, Sk, Dh)), 'v_cache': _w((lambda *s: torch.randn(*s, dtype=torch.bfloat16) * 0.8)(B, Hkv, Sk, Dh)), 'wq': _w((lambda *s: torch.randn(*s, dtype=torch.bfloat16) * 0.8)(D, Hq * Dh) * D ** (-0.5)), 'wo': _w((lambda *s: torch.randn(*s, dtype=torch.bfloat16) * 0.8)(Hq * Dh, D) * (Hq * Dh) ** (-0.5))}
    _A_in = _A_setup()

    def _B_setup():
        B, S, D, F = (1, 1, 512, 1792)
        return {'x': _w((lambda *s: torch.randn(*s, dtype=torch.bfloat16) * 0.1)(B, S, D)), 'w_gate': _w((lambda *s: torch.randn(*s, dtype=torch.bfloat16) * 0.2)(D, F)), 'w_up': _w((lambda *s: torch.randn(*s, dtype=torch.bfloat16) * 0.1)(D, F)), 'w_down': _w((lambda *s: torch.randn(*s, dtype=torch.bfloat16) * 0.1)(F, D))}
    _B_in = _B_setup()
    return {'A_x': _A_in['x'], 'A_k_cache': _A_in['k_cache'], 'A_v_cache': _A_in['v_cache'], 'A_wq': _A_in['wq'], 'A_wo': _A_in['wo'], 'B_x': _B_in['x'], 'B_w_gate': _B_in['w_gate'], 'B_w_up': _B_in['w_up'], 'B_w_down': _B_in['w_down'], 'c': _w((lambda *s: torch.randn(*s, dtype=torch.bfloat16) * 0.4)(1, 512) * 8.0), 'w_mod': _w((lambda *s: torch.randn(*s, dtype=torch.bfloat16) * 0.4)(512, 6 * 512) * 512 ** (-0.5) * 8.0)}

def reference(A_x, A_k_cache, A_v_cache, A_wq, A_wo, B_x, B_w_gate, B_w_up, B_w_down, c, w_mod):

    def _A_ref(x, k_cache, v_cache, wq, wo):
        B, Sq, D = x.shape
        Hq, Dh = (32, 128)
        Hkv, Sk = (k_cache.shape[1], k_cache.shape[2])
        W = min(4096, max(256, Sk // 4))
        rep = Hq // Hkv
        q = (lambda x, *d: x.permute(*d))((x @ wq).reshape(B, Sq, Hq, Dh), 0, 2, 1, 3)
        k = (lambda x, n, axis: torch.repeat_interleave(x, n, dim=axis))(k_cache[:, :, Sk - W:, :], rep, axis=1)
        v = (lambda x, n, axis: torch.repeat_interleave(x, n, dim=axis))(v_cache[:, :, Sk - W:, :], rep, axis=1)
        scores = torch.einsum('bhqd,bhkd->bhqk', q, k) * Dh ** (-0.5)
        p = _softmax(scores, axis=-1)
        o = torch.einsum('bhqk,bhkd->bhqd', p, v)
        return (lambda x, *d: x.permute(*d))(o, 0, 2, 1, 3).reshape(B, Sq, Hq * Dh) @ wo

    def _B_ref(x, w_gate, w_up, w_down):
        g = torch.einsum('bsd,df->bsf', x, w_gate)
        u = torch.einsum('bsd,df->bsf', x, w_up)
        h = _sigmoid(g) * u
        return torch.einsum('bsf,fd->bsd', h, w_down)
    x = A_x
    mod = (_silu(c) @ w_mod).reshape(c.shape[0], 6, 1, -1)
    sa, ca, ga, sb, cb, gb = (mod[:, 0].clone(), mod[:, 1].clone(), mod[:, 2].clone(), mod[:, 3].clone(), mod[:, 4].clone(), mod[:, 5].clone())
    h = _layernorm(x, axis=-1) * (1 + ca) + sa
    x = x + ga * _A_ref(h, A_k_cache, A_v_cache, A_wq, A_wo)
    h = _layernorm(x, axis=-1) * (1 + cb) + sb
    x = x + gb * _B_ref(h, B_w_gate, B_w_up, B_w_down)
    return x
```

```asm
; @launch grid=(256,1,1) block=(576,1,1) lds=138752
.amdgcn_target "amdgcn-amd-amdhsa--gfx950"
.text
.globl adaLN_cond__sliding_block_cached__glu_gated_glu__decode_kernel
.p2align 8
.type adaLN_cond__sliding_block_cached__glu_gated_glu__decode_kernel,@function
adaLN_cond__sliding_block_cached__glu_gated_glu__decode_kernel:
    s_cmp_ge_u32 s2, 256
    s_cbranch_scc1 L_exit
    s_load_dwordx2 s[8:9], s[0:1], 104
    s_load_dword s62, s[0:1], 0
    s_and_b32 s4, s2, 7
    s_lshr_b32 s5, s2, 3
    v_lshrrev_b32 v2, 6, v0
    v_and_b32 v1, 63, v0
    s_add_u32 s7, s5, 16
    s_sub_u32 s42, s5, 8
    s_cmp_lt_u32 s5, 8
    s_cselect_b32 s42, s7, s42
    s_cmp_lt_u32 s5, 24
    s_cselect_b32 s5, s42, s5
    s_mov_b32 s7, 0
    v_readfirstlane_b32 s3, v2
    s_mov_b32 s10, 0x10000000
    s_mov_b32 s11, 0x20000
    v_and_b32 v3, 15, v1
    v_lshrrev_b32 v4, 4, v1
    s_cmp_lg_u32 s3, 8
    s_cbranch_scc1 L_work
    s_getpc_b64 s[52:53]
L_pc:
    s_sub_u32 s52, s52, L_pc-adaLN_cond__sliding_block_cached__glu_gated_glu__decode_kernel
    s_subb_u32 s53, s53, 0
    v_lshlrev_b32 v20, 7, v1
    v_add_u32 v21, 0, v20
    v_min_u32 v21, L_code_end-adaLN_cond__sliding_block_cached__glu_gated_glu__decode_kernel-4, v21
    global_load_dword v23, v21, s[52:53]
    v_add_u32 v22, 8192, v20
    v_min_u32 v22, L_code_end-adaLN_cond__sliding_block_cached__glu_gated_glu__decode_kernel-4, v22
    global_load_dword v24, v22, s[52:53]
    s_setprio 3
    s_cmp_ge_u32 s5, 24
    s_cbranch_scc1 L_M_comm
    s_cmp_lt_u32 s5, 16
    s_cbranch_scc1 L_A_comm
    s_branch L_F_comm
L_work:
    s_cmp_lt_u32 s5, 16
    s_cbranch_scc1 L_Ai
    s_load_dwordx2 s[12:13], s[0:1], 80
    s_load_dwordx2 s[20:21], s[0:1], 72
    s_load_dwordx2 s[16:17], s[0:1], 24
    s_mov_b32 s14, 0x300000
    s_mov_b32 s15, 0x20000
    s_mov_b32 s22, 0x400
    s_mov_b32 s23, 0x20000
    s_mov_b32 s18, 0x400000
    s_mov_b32 s19, 0x20000
    v_lshlrev_b32 v7, 1, v1
    v_lshlrev_b32 v9, 4, v4
    v_lshlrev_b32 v17, 2, v1
    s_mov_b32 s57, 0x3fb8aa3b
    s_and_b32 s58, s5, 7
    s_cmp_ge_u32 s5, 24
    s_cbranch_scc1 L_M
    v_mul_u32_u24 v5, 49152, v4
    v_lshl_add_u32 v5, v3, 2, v5
    s_lshl_b32 s40, s4, 7
    s_mul_i32 s56, s4, 393216
    s_lshl_b32 s59, s58, 2
    s_add_u32 s59, s59, s3
    s_lshl_b32 s42, s59, 6
    s_add_u32 s41, s56, s42
    s_waitcnt lgkmcnt(0)
    buffer_load_ushort v8, v7, s[20:23], s40 offen
    s_load_dword s45, s[8:9], 0
    s_mov_b32 s46, 0xfffffc00
    s_mov_b32 s50, 0x05040100
    s_mov_b32 s51, 0x07060302
    s_cmp_ge_u32 s3, 4
    s_cbranch_scc1 L_F_wq
    buffer_load_dword v32, v5, s[12:15], s41 offen
    s_add_u32 s41, s41, 6144
    buffer_load_dword v33, v5, s[12:15], s41 offen
    s_add_u32 s41, s41, 6144
    buffer_load_dword v34, v5, s[12:15], s41 offen
    s_add_u32 s41, s41, 6144
    buffer_load_dword v35, v5, s[12:15], s41 offen
    s_add_u32 s41, s41, 6144
    buffer_load_dword v36, v5, s[12:15], s41 offen
    s_add_u32 s41, s41, 6144
    buffer_load_dword v37, v5, s[12:15], s41 offen
    s_add_u32 s41, s41, 6144
    buffer_load_dword v38, v5, s[12:15], s41 offen
    s_add_u32 s41, s41, 6144
    buffer_load_dword v39, v5, s[12:15], s41 offen
    s_add_u32 s41, s41, 153600
    buffer_load_dword v40, v5, s[12:15], s41 offen
    s_add_u32 s41, s41, 6144
    buffer_load_dword v41, v5, s[12:15], s41 offen
    s_add_u32 s41, s41, 6144
    buffer_load_dword v42, v5, s[12:15], s41 offen
    s_add_u32 s41, s41, 6144
    buffer_load_dword v43, v5, s[12:15], s41 offen
    s_add_u32 s41, s41, 6144
    buffer_load_dword v44, v5, s[12:15], s41 offen
    s_add_u32 s41, s41, 6144
    buffer_load_dword v45, v5, s[12:15], s41 offen
    s_add_u32 s41, s41, 6144
    buffer_load_dword v46, v5, s[12:15], s41 offen
    s_add_u32 s41, s41, 6144
    buffer_load_dword v47, v5, s[12:15], s41 offen
    s_and_b32 s55, s59, 15
    s_lshl_b32 s55, s55, 17
    s_bfe_u32 s42, s59, 0x20004
    s_lshl_b32 s42, s42, 11
    s_add_u32 s55, s55, s42
    s_lshr_b32 s42, s59, 6
    s_lshl_b32 s42, s42, 14
    s_add_u32 s55, s55, s42
    s_add_u32 s55, s55, 32768
    s_waitcnt lgkmcnt(0)
    s_add_u32 s45, s45, 1
    s_and_b32 s6, s45, 1023
    v_mov_b32 v2, s6
    s_lshl_b32 s42, s3, 7
    v_add_u32 v13, s42, v7
    v_add_u32 v14, s42, v9
    s_waitcnt vmcnt(16)
    v_lshlrev_b32 v8, 16, v8
    v_mul_f32 v15, s57, v8
    v_max_f32 v15, 0xc2fc0000, v15
    v_exp_f32 v15, -v15
    s_nop 0
    v_add_f32 v15, 1.0, v15
    v_rcp_f32 v16, v15
    s_nop 0
    v_mul_f32 v18, v8, v16
    v_fma_f32 v15, -v18, v15, v8
    v_fma_f32 v15, v15, v16, v18
    v_cvt_pk_bf16_f32 v15, 0, v15
    ds_write_b16_d16_hi v13, v15
    ds_read_b128 v[20:23], v14
    ds_read_b128 v[24:27], v14 offset:64
    s_waitcnt vmcnt(0)
    v_perm_b32 v48, v33, v32, s50
    v_perm_b32 v49, v35, v34, s50
    v_perm_b32 v50, v37, v36, s50
    v_perm_b32 v51, v39, v38, s50
    v_perm_b32 v52, v33, v32, s51
    v_perm_b32 v53, v35, v34, s51
    v_perm_b32 v54, v37, v36, s51
    v_perm_b32 v55, v39, v38, s51
    v_perm_b32 v56, v41, v40, s50
    v_perm_b32 v57, v43, v42, s50
    v_perm_b32 v58, v45, v44, s50
    v_perm_b32 v59, v47, v46, s50
    v_perm_b32 v60, v41, v40, s51
    v_perm_b32 v61, v43, v42, s51
    v_perm_b32 v62, v45, v44, s51
    v_perm_b32 v63, v47, v46, s51
    s_waitcnt lgkmcnt(0)
    v_mfma_f32_16x16x32_bf16 v[32:35], v[20:23], v[48:51], 0
    v_mfma_f32_16x16x32_bf16 v[36:39], v[20:23], v[52:55], 0
    v_mfma_f32_16x16x32_bf16 v[32:35], v[24:27], v[56:59], v[32:35]
    v_mfma_f32_16x16x32_bf16 v[36:39], v[24:27], v[60:63], v[36:39]
    v_lshlrev_b32 v15, 4, v3
    s_lshl_b32 s42, s4, 8
    s_add_u32 s42, s42, s55
    v_mov_b32 v29, s45
    v_mov_b32 v31, s45
    s_mov_b64 exec, 0xffff
    s_nop 0
    v_mov_b32 v28, v32
    v_mov_b32 v30, v36
    buffer_store_dwordx4 v[28:31], v15, s[8:11], s42 offen sc1
    s_mov_b64 exec, -1
    s_branch L_F_j
L_F_wq:
    v_xor_b32 v64, 0, v1
    v_lshlrev_b32 v64, 4, v64
    v_xor_b32 v65, 2, v1
    v_lshlrev_b32 v65, 4, v65
    v_xor_b32 v66, 4, v1
    v_lshlrev_b32 v66, 4, v66
    v_xor_b32 v67, 6, v1
    v_lshlrev_b32 v67, 4, v67
    v_xor_b32 v68, 8, v1
    v_lshlrev_b32 v68, 4, v68
    v_xor_b32 v69, 10, v1
    v_lshlrev_b32 v69, 4, v69
    v_xor_b32 v70, 12, v1
    v_lshlrev_b32 v70, 4, v70
    v_xor_b32 v71, 14, v1
    v_lshlrev_b32 v71, 4, v71
    s_and_b32 s42, s3, 3
    s_lshl_b32 s44, s42, 14
    s_lshl_b32 s42, s42, 17
    s_lshl_b32 s62, s58, 19
    s_add_u32 s62, s62, s42
    s_lshl_b32 s42, s4, 10
    s_add_u32 s62, s62, s42
    s_add_u32 m0, s44, 8192
    s_nop 0
    buffer_load_dwordx4 v64, s[16:19], s62 offen offset:0 lds
    s_add_u32 s62, s62, 7168
    buffer_load_dwordx4 v65, s[16:19], s62 offen offset:1024 lds
    s_add_u32 s62, s62, 7168
    buffer_load_dwordx4 v66, s[16:19], s62 offen offset:2048 lds
    s_add_u32 s62, s62, 7168
    buffer_load_dwordx4 v67, s[16:19], s62 offen offset:3072 lds
    s_add_u32 m0, s44, 12288
    s_add_u32 s62, s62, 11264
    buffer_load_dwordx4 v64, s[16:19], s62 offen offset:0 lds
    s_add_u32 s62, s62, 7168
    buffer_load_dwordx4 v65, s[16:19], s62 offen offset:1024 lds
    s_add_u32 s62, s62, 7168
    buffer_load_dwordx4 v66, s[16:19], s62 offen offset:2048 lds
    s_add_u32 s62, s62, 7168
    buffer_load_dwordx4 v67, s[16:19], s62 offen offset:3072 lds
    s_add_u32 m0, s44, 16384
    s_add_u32 s62, s62, 11264
    buffer_load_dwordx4 v68, s[16:19], s62 offen offset:0 lds
    s_add_u32 s62, s62, 7168
    buffer_load_dwordx4 v69, s[16:19], s62 offen offset:1024 lds
    s_add_u32 s62, s62, 7168
    buffer_load_dwordx4 v70, s[16:19], s62 offen offset:2048 lds
    s_add_u32 s62, s62, 7168
    buffer_load_dwordx4 v71, s[16:19], s62 offen offset:3072 lds
    s_add_u32 m0, s44, 20480
    s_add_u32 s62, s62, 11264
    buffer_load_dwordx4 v68, s[16:19], s62 offen offset:0 lds
    s_add_u32 s62, s62, 7168
    buffer_load_dwordx4 v69, s[16:19], s62 offen offset:1024 lds
    s_add_u32 s62, s62, 7168
    buffer_load_dwordx4 v70, s[16:19], s62 offen offset:2048 lds
    s_add_u32 s62, s62, 7168
    buffer_load_dwordx4 v71, s[16:19], s62 offen offset:3072 lds
    s_branch L_F_j
L_Ai:
    s_load_dwordx2 s[20:21], s[0:1], 24
    s_load_dwordx2 s[12:13], s[0:1], 8
    s_load_dwordx2 s[16:17], s[0:1], 16
    s_mov_b32 s14, 0x2000000
    s_mov_b32 s15, 0x20000
    s_mov_b32 s18, 0x2000000
    s_mov_b32 s19, 0x20000
    s_mov_b32 s22, 0x400000
    s_mov_b32 s23, 0x20000
    v_bfe_u32 v14, v1, 3, 1
    v_lshlrev_b32 v14, 13, v14
    v_and_b32 v6, 7, v1
    v_lshl_add_u32 v14, v6, 7, v14
    v_lshl_add_u32 v14, v4, 5, v14
    s_lshr_b32 s44, s5, 1
    s_lshl_b32 s44, s44, 5
    s_and_b32 s41, s5, 1
    s_lshl_b32 s41, s41, 3
    s_add_u32 s44, s44, s41
    s_add_u32 s44, s44, s3
    s_lshl_b32 s44, s44, 14
    s_lshl_b32 s41, s4, 10
    s_add_u32 s44, s44, s41
    v_lshlrev_b32 v5, 8, v4
    v_add_u32 v6, 0, v4
    v_xor_b32 v6, v6, v3
    v_lshl_add_u32 v8, v6, 4, v5
    v_add_u32 v6, 4, v4
    v_xor_b32 v6, v6, v3
    v_lshl_add_u32 v9, v6, 4, v5
    v_add_u32 v6, 8, v4
    v_xor_b32 v6, v6, v3
    v_lshl_add_u32 v10, v6, 4, v5
    v_add_u32 v6, 12, v4
    v_xor_b32 v6, v6, v3
    v_lshl_add_u32 v11, v6, 4, v5
    v_add_u32 v6, 0, v4
    v_lshlrev_b32 v6, 1, v6
    v_xor_b32 v6, v6, v3
    v_lshl_add_u32 v12, v6, 4, v5
    v_add_u32 v6, 4, v4
    v_lshlrev_b32 v6, 1, v6
    v_xor_b32 v6, v6, v3
    v_lshl_add_u32 v13, v6, 4, v5
    s_lshl_b32 s40, s4, 22
    s_lshl_b32 s41, s5, 16
    s_add_u32 s40, s40, s41
    s_lshl_b32 s41, s3, 13
    s_add_u32 s40, s40, s41
    s_add_u32 s40, s40, 3145728
    s_add_u32 s43, s40, 4096
    s_mov_b32 m0, s41
    s_waitcnt lgkmcnt(0)
    s_load_dword s45, s[8:9], 0
    s_mov_b32 s46, 0xfffffc00
    s_mov_b32 s50, 0x05040100
    s_mov_b32 s51, 0x07060302
    buffer_load_dword v104, v14, s[20:23], s44 offen
    s_waitcnt vmcnt(0)
    buffer_load_dwordx4 v8, s[12:15], s40 offen offset:0 nt lds
    buffer_load_dwordx4 v9, s[12:15], s40 offen offset:1024 nt lds
    buffer_load_dwordx4 v10, s[12:15], s40 offen offset:2048 nt lds
    buffer_load_dwordx4 v11, s[12:15], s40 offen offset:3072 nt lds
    s_add_u32 m0, s41, 4096
    s_nop 0
    buffer_load_dwordx4 v8, s[12:15], s43 offen offset:0 nt lds
    buffer_load_dwordx4 v9, s[12:15], s43 offen offset:1024 nt lds
    buffer_load_dwordx4 v10, s[12:15], s43 offen offset:2048 nt lds
    buffer_load_dwordx4 v11, s[12:15], s43 offen offset:3072 nt lds
    s_barrier
    s_add_u32 m0, s41, 65536
    s_nop 0
    buffer_load_dwordx4 v12, s[16:19], s40 offen offset:0 nt lds
    buffer_load_dwordx4 v13, s[16:19], s40 offen offset:1024 nt lds
    buffer_load_dwordx4 v12, s[16:19], s40 offen offset:2048 nt lds
    buffer_load_dwordx4 v13, s[16:19], s40 offen offset:3072 nt lds
    s_add_u32 m0, s41, 69632
    s_nop 0
    buffer_load_dwordx4 v12, s[16:19], s43 offen offset:0 nt lds
    buffer_load_dwordx4 v13, s[16:19], s43 offen offset:1024 nt lds
    buffer_load_dwordx4 v12, s[16:19], s43 offen offset:2048 nt lds
    buffer_load_dwordx4 v13, s[16:19], s43 offen offset:3072 nt lds
    s_branch L_A
L_M:
    s_load_dwordx2 s[24:25], s[0:1], 0
    s_load_dwordx2 s[28:29], s[0:1], 48
    s_load_dwordx2 s[32:33], s[0:1], 56
    s_load_dwordx2 s[36:37], s[0:1], 64
    s_mov_b32 s26, 0x400
    s_mov_b32 s27, 0x20000
    s_mov_b32 s30, 0x1c0000
    s_mov_b32 s31, 0x20000
    s_mov_b32 s34, 0x1c0000
    s_mov_b32 s35, 0x20000
    s_mov_b32 s38, 0x1c0000
    s_mov_b32 s39, 0x20000
    v_bfe_u32 v10, v1, 3, 2
    v_lshlrev_b32 v10, 13, v10
    v_and_b32 v6, 7, v1
    v_lshl_add_u32 v10, v6, 7, v10
    v_lshrrev_b32 v6, 5, v1
    v_lshl_add_u32 v10, v6, 6, v10
    s_lshl_b32 s43, s58, 4
    s_add_u32 s43, s43, s3
    s_add_u32 s43, s43, 8
    s_lshl_b32 s43, s43, 15
    s_lshl_b32 s42, s4, 10
    s_add_u32 s43, s43, s42
    v_and_b32 v11, 31, v1
    s_waitcnt lgkmcnt(0)
    s_load_dword s45, s[8:9], 0
    s_mov_b32 s46, 0xfffffc00
    s_mov_b32 s50, 0x05040100
    s_mov_b32 s51, 0x07060302
    buffer_load_dword v112, v10, s[16:19], s43 offen
    s_waitcnt lgkmcnt(0)
    s_add_u32 s45, s45, 1
    s_and_b32 s6, s45, 1023
    v_mov_b32 v2, s6
    s_branch L_M2
L_F_j:
    s_load_dwordx2 s[36:37], s[0:1], 64
    s_mov_b32 s38, 0x1c0000
    s_mov_b32 s39, 0x20000
    s_cmp_lt_u32 s3, 4
    s_cbranch_scc1 L_F_j2
    s_waitcnt lgkmcnt(0)
    s_add_u32 s45, s45, 1
    s_and_b32 s6, s45, 1023
    v_mov_b32 v2, s6
    s_lshl_b32 s42, s3, 7
    v_add_u32 v13, s42, v7
    v_add_u32 v14, s42, v9
    s_waitcnt vmcnt(16)
    v_lshlrev_b32 v8, 16, v8
    v_mul_f32 v15, s57, v8
    v_max_f32 v15, 0xc2fc0000, v15
    v_exp_f32 v15, -v15
    s_nop 0
    v_add_f32 v15, 1.0, v15
    v_rcp_f32 v16, v15
    s_nop 0
    v_mul_f32 v18, v8, v16
    v_fma_f32 v15, -v18, v15, v8
    v_fma_f32 v15, v15, v16, v18
    v_cvt_pk_bf16_f32 v15, 0, v15
    ds_write_b16_d16_hi v13, v15
    ds_read_b128 v[20:23], v14
    ds_read_b128 v[24:27], v14 offset:64
L_F_j2:
    v_lshrrev_b32 v5, 2, v3
    v_mov_b32 v28, 0
    v_add_u32 v29, 1280, v7
    ds_write_b16 v29, v28
    v_bfe_u32 v18, v1, 1, 1
    v_and_b32 v28, 1, v1
    v_and_b32 v29, 1, v4
    v_lshl_add_u32 v29, v29, 2, v5
    v_lshlrev_b32 v29, 1, v29
    v_xor_b32 v29, v29, v18
    v_lshlrev_b32 v29, 4, v29
    v_lshl_add_u32 v29, v28, 3, v29
    v_lshl_add_u32 v29, v5, 10, v29
    v_lshl_add_u32 v29, v4, 13, v29
    s_lshl_b32 s42, s3, 7
    v_xor_b32 v29, s42, v29
    v_add_u32 v29, 8192, v29
    v_xor_b32 v96, 0, v29
    v_xor_b32 v97, 32, v29
    v_xor_b32 v98, 64, v29
    v_xor_b32 v99, 96, v29
    v_lshlrev_b32 v28, 4, v4
    v_add_u32 v28, 1024, v28
    v_mov_b32 v29, 1280
    v_cmp_eq_u32 vcc, 0, v5
    s_nop 1
    v_cndmask_b32 v100, v29, v28, vcc
    v_cmp_eq_u32 vcc, 1, v5
    s_nop 1
    v_cndmask_b32 v101, v29, v28, vcc
    v_cmp_eq_u32 vcc, 2, v5
    s_nop 1
    v_cndmask_b32 v102, v29, v28, vcc
    v_cmp_eq_u32 vcc, 3, v5
    s_nop 1
    v_cndmask_b32 v103, v29, v28, vcc
    v_mov_b32 v11, 1152
    v_lshlrev_b32 v18, 3, v1
    v_mov_b32 v31, s45
    s_lshl_b32 s54, s4, 3
    s_add_u32 s54, s54, s3
    s_lshl_b32 s54, s54, 3
    s_add_u32 s54, s54, s58
    s_lshl_b32 s54, s54, 9
    s_add_u32 s54, s54, 2359296
    s_cmp_lt_u32 s3, 4
    s_cbranch_scc1 L_F_k
    s_waitcnt vmcnt(0)
L_F_k:
    s_waitcnt lgkmcnt(0)
    s_barrier
    ds_read_b64_tr_b16 v[32:33], v96 offset:0
    ds_read_b64_tr_b16 v[34:35], v96 offset:4096
    ds_read_b64_tr_b16 v[36:37], v97 offset:0
    ds_read_b64_tr_b16 v[38:39], v97 offset:4096
    ds_read_b64_tr_b16 v[40:41], v98 offset:0
    ds_read_b64_tr_b16 v[42:43], v98 offset:4096
    ds_read_b64_tr_b16 v[44:45], v99 offset:0
    ds_read_b64_tr_b16 v[46:47], v99 offset:4096
    ds_read_b64_tr_b16 v[48:49], v96 offset:32768
    ds_read_b64_tr_b16 v[50:51], v96 offset:36864
    ds_read_b64_tr_b16 v[52:53], v97 offset:32768
    ds_read_b64_tr_b16 v[54:55], v97 offset:36864
    ds_read_b64_tr_b16 v[56:57], v98 offset:32768
    ds_read_b64_tr_b16 v[58:59], v98 offset:36864
    ds_read_b64_tr_b16 v[60:61], v99 offset:32768
    ds_read_b64_tr_b16 v[62:63], v99 offset:36864
    s_waitcnt lgkmcnt(0)
    s_barrier
    ds_read_b64 v[28:29], v11
    ds_read_b128 v[64:67], v100 offset:0
    ds_read_b128 v[68:71], v101 offset:0
    ds_read_b128 v[72:75], v102 offset:0
    ds_read_b128 v[76:79], v103 offset:0
    ds_read_b128 v[80:83], v100 offset:64
    ds_read_b128 v[84:87], v101 offset:64
    ds_read_b128 v[88:91], v102 offset:64
    ds_read_b128 v[92:95], v103 offset:64
    s_waitcnt lgkmcnt(7)
    v_mfma_f32_16x16x32_bf16 v[108:111], v[64:67], v[32:35], 0
    v_readfirstlane_b32 s7, v28
    v_readfirstlane_b32 s76, v29
    s_waitcnt lgkmcnt(6)
    v_mfma_f32_16x16x32_bf16 v[112:115], v[68:71], v[36:39], 0
    s_waitcnt lgkmcnt(5)
    v_mfma_f32_16x16x32_bf16 v[108:111], v[72:75], v[40:43], v[108:111]
    s_waitcnt lgkmcnt(4)
    v_mfma_f32_16x16x32_bf16 v[112:115], v[76:79], v[44:47], v[112:115]
    s_waitcnt lgkmcnt(3)
    v_mfma_f32_16x16x32_bf16 v[108:111], v[80:83], v[48:51], v[108:111]
    s_waitcnt lgkmcnt(2)
    v_mfma_f32_16x16x32_bf16 v[112:115], v[84:87], v[52:55], v[112:115]
    s_waitcnt lgkmcnt(1)
    v_mfma_f32_16x16x32_bf16 v[108:111], v[88:91], v[56:59], v[108:111]
    s_waitcnt lgkmcnt(0)
    v_mfma_f32_16x16x32_bf16 v[112:115], v[92:95], v[60:63], v[112:115]
    s_nop 7
    v_add_f32 v30, v108, v112
    s_cmp_eq_u32 s7, 1
    s_cbranch_scc0 S_1_s
    buffer_store_dwordx2 v[30:31], v18, s[8:11], s54 offen
S_1_e:
    v_mul_u32_u24 v5, 49152, v4
    v_lshl_add_u32 v5, v3, 2, v5
    s_lshl_b32 s59, s58, 3
    s_add_u32 s59, s59, s3
    s_add_u32 s59, s59, 32
    s_lshl_b32 s42, s59, 6
    s_add_u32 s41, s56, s42
    s_and_b32 s55, s59, 15
    s_lshl_b32 s55, s55, 17
    s_bfe_u32 s42, s59, 0x20004
    s_lshl_b32 s42, s42, 11
    s_add_u32 s55, s55, s42
    s_lshr_b32 s42, s59, 6
    s_lshl_b32 s42, s42, 14
    s_add_u32 s55, s55, s42
    s_add_u32 s55, s55, 32768
    v_lshlrev_b32 v6, 7, v1
    s_mul_i32 s40, s4, 229376
    s_mul_i32 s42, s58, 28672
    s_add_u32 s40, s40, s42
    s_lshl_b32 s42, s3, 13
    s_add_u32 s40, s40, s42
    s_barrier
    buffer_load_dword v32, v5, s[12:15], s41 offen
    s_add_u32 s41, s41, 6144
    buffer_load_dword v33, v5, s[12:15], s41 offen
    s_add_u32 s41, s41, 6144
    buffer_load_dword v34, v5, s[12:15], s41 offen
    s_add_u32 s41, s41, 6144
    buffer_load_dword v35, v5, s[12:15], s41 offen
    s_add_u32 s41, s41, 6144
    buffer_load_dword v36, v5, s[12:15], s41 offen
    s_add_u32 s41, s41, 6144
    buffer_load_dword v37, v5, s[12:15], s41 offen
    s_add_u32 s41, s41, 6144
    buffer_load_dword v38, v5, s[12:15], s41 offen
    s_add_u32 s41, s41, 6144
    buffer_load_dword v39, v5, s[12:15], s41 offen
    s_add_u32 s41, s41, 153600
    buffer_load_dword v40, v5, s[12:15], s41 offen
    s_add_u32 s41, s41, 6144
    buffer_load_dword v41, v5, s[12:15], s41 offen
    s_add_u32 s41, s41, 6144
    buffer_load_dword v42, v5, s[12:15], s41 offen
    s_add_u32 s41, s41, 6144
    buffer_load_dword v43, v5, s[12:15], s41 offen
    s_add_u32 s41, s41, 6144
    buffer_load_dword v44, v5, s[12:15], s41 offen
    s_add_u32 s41, s41, 6144
    buffer_load_dword v45, v5, s[12:15], s41 offen
    s_add_u32 s41, s41, 6144
    buffer_load_dword v46, v5, s[12:15], s41 offen
    s_add_u32 s41, s41, 6144
    buffer_load_dword v47, v5, s[12:15], s41 offen
    s_waitcnt vmcnt(0)
    ds_read_b32 v29, v11 offset:4
    s_waitcnt lgkmcnt(0)
    v_readfirstlane_b32 s76, v29
    v_perm_b32 v48, v33, v32, s50
    v_perm_b32 v49, v35, v34, s50
    v_perm_b32 v50, v37, v36, s50
    v_perm_b32 v51, v39, v38, s50
    v_perm_b32 v52, v33, v32, s51
    v_perm_b32 v53, v35, v34, s51
    v_perm_b32 v54, v37, v36, s51
    v_perm_b32 v55, v39, v38, s51
    v_perm_b32 v56, v41, v40, s50
    v_perm_b32 v57, v43, v42, s50
    v_perm_b32 v58, v45, v44, s50
    v_perm_b32 v59, v47, v46, s50
    v_perm_b32 v60, v41, v40, s51
    v_perm_b32 v61, v43, v42, s51
    v_perm_b32 v62, v45, v44, s51
    v_perm_b32 v63, v47, v46, s51
    s_waitcnt lgkmcnt(0)
    v_mfma_f32_16x16x32_bf16 v[32:35], v[20:23], v[48:51], 0
    v_mfma_f32_16x16x32_bf16 v[36:39], v[20:23], v[52:55], 0
    v_mfma_f32_16x16x32_bf16 v[32:35], v[24:27], v[56:59], v[32:35]
    v_mfma_f32_16x16x32_bf16 v[36:39], v[24:27], v[60:63], v[36:39]
    v_lshlrev_b32 v15, 4, v3
    s_lshl_b32 s42, s4, 8
    s_add_u32 s42, s42, s55
    v_mov_b32 v29, s45
    v_mov_b32 v31, s45
    s_mov_b64 exec, 0xffff
    s_nop 0
    v_mov_b32 v28, v32
    v_mov_b32 v30, v36
    buffer_store_dwordx4 v[28:31], v15, s[8:11], s42 offen sc1
    s_add_u32 s43, s42, 8192
    buffer_store_dwordx4 v[28:31], v15, s[8:11], s43 offen sc1
    s_mov_b64 exec, -1
    s_sub_u32 s42, s59, 80
    s_cbranch_scc1 L_F_all
    s_lshr_b32 s42, s42, 1
    s_cmp_lg_u32 s42, s4
    s_cbranch_scc1 L_F_end
L_F_all:
    s_waitcnt vmcnt(0)
    s_add_u32 s55, s55, s76
    s_mov_b32 s47, 0
P_2:
    buffer_load_dwordx2 v[32:33], v18, s[8:11], s55 offen offset:0 sc1
    buffer_load_dwordx2 v[34:35], v18, s[8:11], s55 offen offset:512 sc1
    buffer_load_dwordx2 v[36:37], v18, s[8:11], s55 offen offset:1024 sc1
    buffer_load_dwordx2 v[38:39], v18, s[8:11], s55 offen offset:1536 sc1
    s_add_u32 s47, s47, 1
    s_cmp_gt_u32 s47, 1000000
    s_cbranch_scc1 P_2_t
    s_waitcnt vmcnt(0)
    v_xor_b32 v30, s45, v33
    v_bitop3_b32 v30, v30, v35, s45 bitop3:0xf6
    v_bitop3_b32 v30, v30, v37, s45 bitop3:0xf6
    v_bitop3_b32 v30, v30, v39, s45 bitop3:0xf6
    v_cmp_ne_u32 vcc, 0, v30
    s_cbranch_vccnz P_2
P_2_x:
    v_add_f32 v32, v32, v34
    v_add_f32 v36, v36, v38
    v_add_f32 v32, v32, v36
    v_mov_b32 v33, v32
    s_nop 1
    v_permlane32_swap_b32 v32, v33
    v_add_f32 v32, v32, v33
    v_cvt_pk_bf16_f32 v32, 0, v32
    s_mul_i32 s42, s4, 12288
    s_lshl_b32 s43, s59, 7
    s_add_u32 s42, s42, s43
    s_add_u32 s42, s42, 2113536
    v_or_b32 v33, v2, v32
    s_mov_b32 exec_hi, 0
    s_cmp_eq_u32 s7, 1
    s_cbranch_scc0 S_3_s
    buffer_store_dword v33, v17, s[8:11], s42 offen
S_3_e:
L_F_end:
    s_endpgm
S_1_s:
    buffer_store_dwordx2 v[30:31], v18, s[8:11], s54 offen sc1
    s_branch S_1_e
P_2_t:
    s_waitcnt vmcnt(0)
    s_branch P_2_x
S_3_s:
    buffer_store_dword v33, v17, s[8:11], s42 offen sc1
    s_branch S_3_e
L_F_comm:
    s_load_dwordx2 s[24:25], s[0:1], 0
    s_mov_b32 s26, 0x400
    s_mov_b32 s27, 0x20000
    s_and_b32 s58, s5, 7
    v_lshlrev_b32 v9, 4, v1
    v_lshlrev_b32 v11, 1, v1
    s_lshl_b32 s40, s58, 7
    s_waitcnt lgkmcnt(0)
    buffer_load_dwordx4 v[32:35], v9, s[24:27], 0 offen
    buffer_load_ushort v36, v11, s[24:27], s40 offen
    s_load_dword s45, s[8:9], 0
    s_mov_b32 s46, 0xfffffc00
    s_mov_b32 s50, 0x05040100
    s_mov_b32 s51, 0x07060302
    s_waitcnt lgkmcnt(0)
    s_add_u32 s45, s45, 1
    s_and_b32 s6, s45, 1023
    v_mov_b32 v2, s6
    s_getreg_b32 s44, hwreg(HW_REG_XCC_ID)
    s_and_b32 s44, s44, 0xffff
    s_lshl_b32 s44, s44, 16
    s_or_b32 s44, s44, s6
    v_mov_b32 v4, s44
    v_mov_b32 v5, s44
    v_mov_b32 v6, s44
    v_mov_b32 v7, s44
    v_mov_b32 v8, 0
    s_lshl_b32 s48, s4, 8
    s_add_u32 s48, s48, 1024
    s_and_b32 s49, s5, 15
    s_lshl_b32 s49, s49, 17
    s_add_u32 s49, s49, s48
    s_lshr_b32 s42, s5, 4
    s_lshl_b32 s42, s42, 7
    s_add_u32 s49, s49, s42
    s_mov_b64 exec, 1
    buffer_store_dwordx4 v[4:7], v8, s[8:11], s49 offen sc1
    s_mov_b64 exec, -1
    v_and_b32 v3, 15, v1
    v_lshlrev_b32 v3, 17, v3
    v_bfe_u32 v8, v1, 4, 1
    v_lshl_add_u32 v3, v8, 7, v3
    s_mov_b32 s76, 0
    s_waitcnt vmcnt(1)
    v_lshlrev_b32 v40, 16, v32
    v_and_b32 v41, 0xffff0000, v32
    v_lshlrev_b32 v42, 16, v33
    v_and_b32 v43, 0xffff0000, v33
    v_lshlrev_b32 v44, 16, v34
    v_and_b32 v45, 0xffff0000, v34
    v_lshlrev_b32 v46, 16, v35
    v_and_b32 v47, 0xffff0000, v35
    v_add_f32 v32, v40, v41
    v_add_f32 v33, v42, v43
    v_add_f32 v34, v44, v45
    v_add_f32 v35, v46, v47
    v_add_f32 v32, v32, v33
    v_add_f32 v34, v34, v35
    v_add_f32 v32, v32, v34
    s_nop 2
    v_add_f32_dpp v32, v32, v32 row_ror:8 row_mask:0xf bank_mask:0xf
    s_nop 1
    v_add_f32_dpp v32, v32, v32 row_ror:4 row_mask:0xf bank_mask:0xf
    s_nop 1
    v_add_f32_dpp v32, v32, v32 row_ror:2 row_mask:0xf bank_mask:0xf
    s_nop 1
    v_add_f32_dpp v32, v32, v32 row_ror:1 row_mask:0xf bank_mask:0xf
    v_mov_b32 v33, v32
    s_nop 1
    v_permlane16_swap_b32 v32, v33
    v_add_f32 v32, v32, v33
    v_mov_b32 v33, v32
    s_nop 1
    v_permlane32_swap_b32 v32, v33
    v_add_f32 v32, v32, v33
    v_mul_f32 v32, 0x3b000000, v32
    v_sub_f32 v40, v40, v32
    v_sub_f32 v41, v41, v32
    v_sub_f32 v42, v42, v32
    v_sub_f32 v43, v43, v32
    v_sub_f32 v44, v44, v32
    v_sub_f32 v45, v45, v32
    v_sub_f32 v46, v46, v32
    v_sub_f32 v47, v47, v32
    v_mul_f32 v40, v40, v40
    v_mul_f32 v41, v41, v41
    v_mul_f32 v42, v42, v42
    v_mul_f32 v43, v43, v43
    v_mul_f32 v44, v44, v44
    v_mul_f32 v45, v45, v45
    v_mul_f32 v46, v46, v46
    v_mul_f32 v47, v47, v47
    v_add_f32 v40, v40, v41
    v_add_f32 v42, v42, v43
    v_add_f32 v44, v44, v45
    v_add_f32 v46, v46, v47
    v_add_f32 v40, v40, v42
    v_add_f32 v44, v44, v46
    v_add_f32 v40, v40, v44
    s_nop 2
    v_add_f32_dpp v40, v40, v40 row_ror:8 row_mask:0xf bank_mask:0xf
    s_nop 1
    v_add_f32_dpp v40, v40, v40 row_ror:4 row_mask:0xf bank_mask:0xf
    s_nop 1
    v_add_f32_dpp v40, v40, v40 row_ror:2 row_mask:0xf bank_mask:0xf
    s_nop 1
    v_add_f32_dpp v40, v40, v40 row_ror:1 row_mask:0xf bank_mask:0xf
    v_mov_b32 v33, v40
    s_nop 1
    v_permlane16_swap_b32 v40, v33
    v_add_f32 v40, v40, v33
    v_mov_b32 v33, v40
    s_nop 1
    v_permlane32_swap_b32 v40, v33
    v_add_f32 v40, v40, v33
    v_mul_f32 v40, 0x3b000000, v40
    v_cvt_pk_bf16_f32 v32, 0, v32
    v_cvt_pk_bf16_f32 v40, 0, v40
    v_add_f32 v40, 0x3727c5ac, v40
    v_cvt_pk_bf16_f32 v40, 0, v40
    v_sqrt_f32 v40, v40
    v_lshlrev_b32 v36, 16, v36
    v_cvt_pk_bf16_f32 v40, 0, v40
    v_sub_f32 v36, v36, v32
    v_cvt_pk_bf16_f32 v36, 0, v36
    v_rcp_f32 v41, v40
    s_nop 0
    v_mul_f32 v42, v36, v41
    v_fma_f32 v40, -v42, v40, v36
    v_fma_f32 v40, v40, v41, v42
    v_cvt_pk_bf16_f32 v28, 0, v40
    v_lshrrev_b32 v12, 5, v1
    v_lshlrev_b32 v12, 17, v12
    v_and_b32 v10, 31, v1
    v_lshl_add_u32 v12, v10, 3, v12
    s_lshl_b32 s41, s58, 18
    s_add_u32 s41, s41, 32768
    s_add_u32 s41, s41, s76
    v_add_u32 v13, 1024, v11
    v_mov_b32 v14, 1152
    v_lshlrev_b32 v17, 2, v1
    v_lshlrev_b32 v18, 3, v1
    s_lshl_b32 s54, s4, 3
    s_add_u32 s54, s54, s58
    s_lshl_b32 s55, s54, 8
    s_add_u32 s55, s55, 2097152
    s_lshl_b32 s54, s54, 12
    s_add_u32 s54, s54, 2359296
    v_lshlrev_b32 v19, 6, v1
    v_mov_b32 v20, s45
    s_lshl_b32 s56, s4, 12
    s_lshl_b32 s42, s58, 2
    s_add_u32 s56, s56, s42
    s_add_u32 s56, s56, 2228224
    s_barrier
    buffer_load_dwordx4 v[64:67], v3, s[8:11], s48 offen sc1
    s_mov_b32 s47, 0
P_4:
    buffer_load_dwordx2 v[32:33], v12, s[8:11], s41 offen offset:0 sc1
    buffer_load_dwordx2 v[34:35], v12, s[8:11], s41 offen offset:256 sc1
    buffer_load_dwordx2 v[36:37], v12, s[8:11], s41 offen offset:512 sc1
    buffer_load_dwordx2 v[38:39], v12, s[8:11], s41 offen offset:768 sc1
    buffer_load_dwordx2 v[40:41], v12, s[8:11], s41 offen offset:1024 sc1
    buffer_load_dwordx2 v[42:43], v12, s[8:11], s41 offen offset:1280 sc1
    buffer_load_dwordx2 v[44:45], v12, s[8:11], s41 offen offset:1536 sc1
    buffer_load_dwordx2 v[46:47], v12, s[8:11], s41 offen offset:1792 sc1
    buffer_load_dwordx2 v[48:49], v12, s[8:11], s41 offen offset:2048 sc1
    buffer_load_dwordx2 v[50:51], v12, s[8:11], s41 offen offset:2304 sc1
    buffer_load_dwordx2 v[52:53], v12, s[8:11], s41 offen offset:2560 sc1
    buffer_load_dwordx2 v[54:55], v12, s[8:11], s41 offen offset:2816 sc1
    buffer_load_dwordx2 v[56:57], v12, s[8:11], s41 offen offset:3072 sc1
    buffer_load_dwordx2 v[58:59], v12, s[8:11], s41 offen offset:3328 sc1
    buffer_load_dwordx2 v[60:61], v12, s[8:11], s41 offen offset:3584 sc1
    buffer_load_dwordx2 v[62:63], v12, s[8:11], s41 offen offset:3840 sc1
    s_add_u32 s47, s47, 1
    s_cmp_gt_u32 s47, 1000000
    s_cbranch_scc1 P_4_t
    s_waitcnt vmcnt(14)
    v_xor_b32 v30, s45, v33
    v_bitop3_b32 v30, v30, v35, s45 bitop3:0xf6
    v_add_f32 v32, v32, v34
    s_waitcnt vmcnt(12)
    v_bitop3_b32 v30, v30, v37, s45 bitop3:0xf6
    v_bitop3_b32 v30, v30, v39, s45 bitop3:0xf6
    v_add_f32 v36, v36, v38
    v_add_f32 v32, v32, v36
    s_waitcnt vmcnt(10)
    v_bitop3_b32 v30, v30, v41, s45 bitop3:0xf6
    v_bitop3_b32 v30, v30, v43, s45 bitop3:0xf6
    v_add_f32 v40, v40, v42
    v_add_f32 v32, v32, v40
    s_waitcnt vmcnt(8)
    v_bitop3_b32 v30, v30, v45, s45 bitop3:0xf6
    v_bitop3_b32 v30, v30, v47, s45 bitop3:0xf6
    v_add_f32 v44, v44, v46
    v_add_f32 v32, v32, v44
    s_waitcnt vmcnt(6)
    v_bitop3_b32 v30, v30, v49, s45 bitop3:0xf6
    v_bitop3_b32 v30, v30, v51, s45 bitop3:0xf6
    v_add_f32 v48, v48, v50
    s_waitcnt vmcnt(4)
    v_bitop3_b32 v30, v30, v53, s45 bitop3:0xf6
    v_bitop3_b32 v30, v30, v55, s45 bitop3:0xf6
    v_add_f32 v52, v52, v54
    v_add_f32 v48, v48, v52
    s_waitcnt vmcnt(2)
    v_bitop3_b32 v30, v30, v57, s45 bitop3:0xf6
    v_bitop3_b32 v30, v30, v59, s45 bitop3:0xf6
    v_add_f32 v56, v56, v58
    v_add_f32 v48, v48, v56
    s_waitcnt vmcnt(0)
    v_bitop3_b32 v30, v30, v61, s45 bitop3:0xf6
    v_bitop3_b32 v30, v30, v63, s45 bitop3:0xf6
    v_cmp_ne_u32 vcc, 0, v30
    v_add_f32 v60, v60, v62
    v_add_f32 v48, v48, v60
    s_cbranch_vccnz P_4
P_4_x:
    v_cvt_pk_bf16_f32 v48, 0, v48
    v_cvt_pk_bf16_f32 v32, 0, v32
    v_add_f32 v48, 1.0, v48
    v_cvt_pk_bf16_f32 v48, 0, v48
    v_mul_f32 v48, v28, v48
    v_cvt_pk_bf16_f32 v48, 0, v48
    v_add_f32 v48, v48, v32
    v_cvt_pk_bf16_f32 v48, 0, v48
    ds_write_b16_d16_hi v13, v48
    v_xor_b32 v64, s44, v64
    v_xor_b32 v65, s44, v65
    v_xor_b32 v66, s44, v66
    v_xor_b32 v67, s44, v67
    v_or3_b32 v64, v64, v65, v66
    v_or_b32 v64, v64, v67
    v_cmp_ne_u32 vcc, 0, v64
    s_nop 1
    s_cmp_eq_u64 vcc, 0
    s_cselect_b32 s7, 1, 0
    v_mov_b32 v64, s7
    v_mov_b32 v65, s76
    ds_write_b64 v14, v[64:65]
    s_waitcnt lgkmcnt(0)
    s_barrier
    s_mov_b32 s47, 0
P_5:
    buffer_load_dwordx2 v[32:33], v18, s[8:11], s54 offen offset:0 sc1
    buffer_load_dwordx2 v[34:35], v18, s[8:11], s54 offen offset:512 sc1
    buffer_load_dwordx2 v[36:37], v18, s[8:11], s54 offen offset:1024 sc1
    buffer_load_dwordx2 v[38:39], v18, s[8:11], s54 offen offset:1536 sc1
    buffer_load_dwordx2 v[40:41], v18, s[8:11], s54 offen offset:2048 sc1
    buffer_load_dwordx2 v[42:43], v18, s[8:11], s54 offen offset:2560 sc1
    buffer_load_dwordx2 v[44:45], v18, s[8:11], s54 offen offset:3072 sc1
    buffer_load_dwordx2 v[46:47], v18, s[8:11], s54 offen offset:3584 sc1
    s_add_u32 s47, s47, 1
    s_cmp_gt_u32 s47, 1000000
    s_cbranch_scc1 P_5_t
    s_waitcnt vmcnt(6)
    v_xor_b32 v30, s45, v33
    v_bitop3_b32 v30, v30, v35, s45 bitop3:0xf6
    v_add_f32 v32, v32, v34
    s_waitcnt vmcnt(4)
    v_bitop3_b32 v30, v30, v37, s45 bitop3:0xf6
    v_bitop3_b32 v30, v30, v39, s45 bitop3:0xf6
    v_add_f32 v36, v36, v38
    v_add_f32 v32, v32, v36
    s_waitcnt vmcnt(2)
    v_bitop3_b32 v30, v30, v41, s45 bitop3:0xf6
    v_bitop3_b32 v30, v30, v43, s45 bitop3:0xf6
    v_add_f32 v40, v40, v42
    v_add_f32 v32, v32, v40
    s_waitcnt vmcnt(0)
    v_bitop3_b32 v30, v30, v45, s45 bitop3:0xf6
    v_bitop3_b32 v30, v30, v47, s45 bitop3:0xf6
    v_cmp_ne_u32 vcc, 0, v30
    v_add_f32 v44, v44, v46
    v_add_f32 v32, v32, v44
    s_cbranch_vccnz P_5
P_5_x:
    v_cvt_pk_bf16_f32 v32, 0, v32
    v_or_b32 v32, v2, v32
    s_cmp_eq_u32 s7, 1
    s_cbranch_scc0 S_6_s
    buffer_store_dword v32, v17, s[8:11], s55 offen
S_6_e:
    s_cmp_lt_u32 s58, 6
    s_cbranch_scc1 L_F_gb
    v_lshlrev_b32 v9, 4, v1
    s_lshl_b32 s40, s4, 10
    s_add_u32 s40, s40, 2211840
    s_mov_b32 s47, 0
P_7:
    buffer_load_dwordx4 v[32:35], v9, s[8:11], s40 offen sc1
    s_add_u32 s47, s47, 1
    s_cmp_gt_u32 s47, 1000000
    s_cbranch_scc1 P_7_t
    s_waitcnt vmcnt(0)
    v_xor_b32 v32, v2, v32
    v_xor_b32 v33, v2, v33
    v_xor_b32 v34, v2, v34
    v_xor_b32 v35, v2, v35
    v_or_b32 v30, v32, v33
    v_or3_b32 v30, v30, v34, v35
    v_and_b32 v30, 1023, v30
    v_cmp_ne_u32 vcc, 0, v30
    s_cbranch_vccz P_7_x
    s_sleep 2
    s_branch P_7
P_7_x:
L_F_gb:
    s_barrier
    s_and_b32 s42, s5, 15
    s_lshl_b32 s42, s42, 17
    s_lshl_b32 s43, s4, 10
    s_add_u32 s42, s42, s43
    s_add_u32 s42, s42, 65536
    s_add_u32 s78, s8, s42
    s_addc_u32 s79, s9, 0
    s_mov_b32 s76, -1
    s_mov_b32 s77, -1
    s_load_dword s42, s[78:79], 0 glc
    s_load_dword s43, s[78:79], 8192 glc
    s_waitcnt lgkmcnt(0)
    s_memtime s[72:73]
    s_waitcnt lgkmcnt(0)
    s_load_dword s42, s[78:79], 0 glc
    s_waitcnt lgkmcnt(0)
    s_memtime s[74:75]
    s_waitcnt lgkmcnt(0)
    s_sub_u32 s74, s74, s72
    s_min_u32 s76, s76, s74
    s_memtime s[72:73]
    s_waitcnt lgkmcnt(0)
    s_load_dword s42, s[78:79], 8192 glc
    s_waitcnt lgkmcnt(0)
    s_memtime s[74:75]
    s_waitcnt lgkmcnt(0)
    s_sub_u32 s74, s74, s72
    s_min_u32 s77, s77, s74
    s_memtime s[72:73]
    s_waitcnt lgkmcnt(0)
    s_load_dword s42, s[78:79], 0 glc
    s_waitcnt lgkmcnt(0)
    s_memtime s[74:75]
    s_waitcnt lgkmcnt(0)
    s_sub_u32 s74, s74, s72
    s_min_u32 s76, s76, s74
    s_memtime s[72:73]
    s_waitcnt lgkmcnt(0)
    s_load_dword s42, s[78:79], 8192 glc
    s_waitcnt lgkmcnt(0)
    s_memtime s[74:75]
    s_waitcnt lgkmcnt(0)
    s_sub_u32 s74, s74, s72
    s_min_u32 s77, s77, s74
    s_memtime s[72:73]
    s_waitcnt lgkmcnt(0)
    s_load_dword s42, s[78:79], 0 glc
    s_waitcnt lgkmcnt(0)
    s_memtime s[74:75]
    s_waitcnt lgkmcnt(0)
    s_sub_u32 s74, s74, s72
    s_min_u32 s76, s76, s74
    s_memtime s[72:73]
    s_waitcnt lgkmcnt(0)
    s_load_dword s42, s[78:79], 8192 glc
    s_waitcnt lgkmcnt(0)
    s_memtime s[74:75]
    s_waitcnt lgkmcnt(0)
    s_sub_u32 s74, s74, s72
    s_min_u32 s77, s77, s74
    s_cmp_lt_u32 s77, s76
    s_cselect_b32 s76, 8192, 0
    v_mov_b32 v65, s76
    ds_write_b32 v14, v65 offset:4
    s_waitcnt lgkmcnt(0)
    s_endpgm
P_4_t:
    s_waitcnt vmcnt(0)
    s_branch P_4_x
P_5_t:
    s_waitcnt vmcnt(0)
    s_branch P_5_x
S_6_s:
    buffer_store_dword v32, v17, s[8:11], s55 offen sc1
    s_branch S_6_e
P_7_t:
    s_waitcnt vmcnt(0)
    s_branch P_7_x
L_A_comm:
    s_load_dwordx2 s[20:21], s[0:1], 32
    s_mov_b32 s22, 0x400000
    s_mov_b32 s23, 0x20000
    s_waitcnt lgkmcnt(0)
    s_load_dword s45, s[8:9], 0
    s_mov_b32 s46, 0xfffffc00
    s_mov_b32 s50, 0x05040100
    s_mov_b32 s51, 0x07060302
    v_mov_b32 v4, 0
    v_mov_b32 v5, 0
    v_mov_b32 v6, 0
    v_mov_b32 v7, 0
    v_mov_b32 v8, 136512
    ds_write_b128 v8, v[4:7]
    v_xor_b32 v64, 0, v1
    v_lshlrev_b32 v64, 4, v64
    v_xor_b32 v65, 2, v1
    v_lshlrev_b32 v65, 4, v65
    v_xor_b32 v66, 4, v1
    v_lshlrev_b32 v66, 4, v66
    v_xor_b32 v67, 6, v1
    v_lshlrev_b32 v67, 4, v67
    v_xor_b32 v68, 8, v1
    v_lshlrev_b32 v68, 4, v68
    v_xor_b32 v69, 10, v1
    v_lshlrev_b32 v69, 4, v69
    v_xor_b32 v70, 12, v1
    v_lshlrev_b32 v70, 4, v70
    v_xor_b32 v71, 14, v1
    v_lshlrev_b32 v71, 4, v71
    s_waitcnt lgkmcnt(0)
    s_add_u32 s45, s45, 1
    s_and_b32 s6, s45, 1023
    v_mov_b32 v2, s6
    s_getreg_b32 s44, hwreg(HW_REG_XCC_ID)
    s_and_b32 s44, s44, 0xffff
    s_lshl_b32 s44, s44, 16
    s_or_b32 s44, s44, s6
    v_mov_b32 v4, s44
    v_mov_b32 v5, s44
    v_mov_b32 v6, s44
    v_mov_b32 v7, s44
    v_mov_b32 v8, 0
    s_lshl_b32 s48, s4, 8
    s_add_u32 s48, s48, 1024
    s_and_b32 s49, s5, 15
    s_lshl_b32 s49, s49, 17
    s_add_u32 s49, s49, s48
    s_lshr_b32 s42, s5, 4
    s_lshl_b32 s42, s42, 7
    s_add_u32 s49, s49, s42
    s_mov_b64 exec, 1
    buffer_store_dwordx4 v[4:7], v8, s[8:11], s49 offen sc1
    s_mov_b64 exec, -1
    v_and_b32 v3, 15, v1
    v_lshlrev_b32 v3, 17, v3
    v_bfe_u32 v8, v1, 4, 1
    v_lshl_add_u32 v3, v8, 7, v3
    s_barrier
    v_lshlrev_b32 v9, 4, v1
    s_lshl_b32 s40, s4, 11
    s_add_u32 s62, s40, 2097152
    v_lshrrev_b32 v10, 5, v1
    v_mul_u32_u24 v10, 272, v10
    v_and_b32 v11, 31, v1
    v_lshl_add_u32 v10, v11, 3, v10
    v_add_u32 v10, 131072, v10
    v_mov_b32 v12, 136576
    s_lshl_b32 s56, s4, 19
    s_lshl_b32 s42, s5, 15
    s_add_u32 s56, s56, s42
    v_and_b32 v14, 3, v1
    v_lshlrev_b32 v13, 5, v14
    v_add_u32 v13, 132224, v13
    v_lshlrev_b32 v14, 8, v14
    s_lshl_b32 s41, s4, 10
    s_lshl_b32 s42, s5, 4
    s_add_u32 s63, s41, s42
    s_add_u32 s63, s63, 2211840
    s_lshr_b32 s42, s5, 2
    s_lshl_b32 s42, s42, 8
    s_add_u32 s41, s41, s42
    s_add_u32 s41, s41, 2211840
    s_lshl_b32 s40, s4, 4
    s_add_u32 s40, s40, s5
    s_lshl_b32 s40, s40, 11
    s_add_u32 s54, s40, 3145728
    s_add_u32 s40, s40, 2883584
    v_and_b32 v15, 15, v1
    v_lshlrev_b32 v15, 4, v15
    v_lshrrev_b32 v16, 4, v1
    v_lshlrev_b32 v16, 4, v16
    v_add_u32 v16, 136448, v16
    v_lshlrev_b32 v17, 2, v1
    s_lshl_b32 s42, s4, 3
    s_lshr_b32 s55, s5, 1
    s_add_u32 s42, s42, s55
    s_and_b32 s55, s42, 15
    s_lshl_b32 s55, s55, 17
    s_lshr_b32 s42, s42, 4
    s_lshl_b32 s42, s42, 8
    s_add_u32 s55, s55, s42
    s_and_b32 s42, s5, 1
    s_lshl_b32 s42, s42, 7
    s_add_u32 s55, s55, s42
    s_add_u32 s55, s55, 4096
    s_mov_b32 s57, 0x3fb8aa3b
    s_and_b32 s55, s5, 1
    s_lshl_b32 s55, s55, 3
    s_lshr_b32 s42, s5, 1
    s_add_u32 s55, s55, s42
    s_lshl_b32 s55, s55, 17
    s_lshl_b32 s42, s4, 8
    s_add_u32 s55, s55, s42
    s_add_u32 s55, s55, 4096
    v_add_u32 v19, 136704, v17
    v_add_u32 v26, 136704, v15
    v_lshlrev_b32 v22, 5, v1
    buffer_load_dword v108, v22, s[8:11], s40 offen sc1
    buffer_load_dword v109, v15, s[8:11], s41 offen sc1
    buffer_load_dwordx4 v[32:35], v9, s[8:11], s62 offen sc1
    buffer_load_dwordx4 v[36:39], v9, s[8:11], s62 offen offset:1024 sc1
    s_waitcnt vmcnt(0)
    buffer_load_dwordx4 v[40:43], v3, s[8:11], s48 offen sc1
    s_mov_b32 s47, 0
P_8:
    buffer_load_dwordx4 v[32:35], v9, s[8:11], s62 offen sc1
    buffer_load_dwordx4 v[36:39], v9, s[8:11], s62 offen offset:1024 sc1
    s_add_u32 s47, s47, 1
    s_cmp_gt_u32 s47, 1000000
    s_cbranch_scc1 P_8_t
    s_waitcnt vmcnt(0)
    v_xor_b32 v32, v2, v32
    v_xor_b32 v33, v2, v33
    v_xor_b32 v34, v2, v34
    v_xor_b32 v35, v2, v35
    v_xor_b32 v36, v2, v36
    v_xor_b32 v37, v2, v37
    v_xor_b32 v38, v2, v38
    v_xor_b32 v39, v2, v39
    v_or_b32 v30, v32, v33
    v_or3_b32 v30, v30, v34, v35
    v_or3_b32 v30, v30, v36, v37
    v_or3_b32 v30, v30, v38, v39
    v_and_b32 v30, 1023, v30
    v_cmp_ne_u32 vcc, 0, v30
    s_cbranch_vccnz P_8
P_8_x:
    v_perm_b32 v44, v33, v32, s51
    v_perm_b32 v45, v35, v34, s51
    ds_write_b64 v10, v[44:45] offset:0
    v_perm_b32 v46, v37, v36, s51
    v_perm_b32 v47, v39, v38, s51
    ds_write_b64 v10, v[46:47] offset:544
    s_waitcnt lgkmcnt(0)
    s_barrier
    s_barrier
    s_waitcnt vmcnt(0)
    v_xor_b32 v40, s44, v40
    v_xor_b32 v41, s44, v41
    v_xor_b32 v42, s44, v42
    v_xor_b32 v43, s44, v43
    v_or3_b32 v40, v40, v41, v42
    v_or_b32 v40, v40, v43
    v_cmp_ne_u32 vcc, 0, v40
    s_nop 1
    s_cmp_eq_u64 vcc, 0
    s_cselect_b32 s7, 1, 0
    v_mov_b32 v18, s7
    ds_write_b32 v12, v18
    v_lshrrev_b32 v20, 1, v14
    v_add_u32 v20, 132352, v20
    v_add_u32 v20, 132352, v17
    v_lshrrev_b32 v22, 4, v1
    v_lshlrev_b32 v21, 5, v22
    v_add_u32 v21, 132224, v21
    v_lshlrev_b32 v22, 8, v22
    s_waitcnt lgkmcnt(0)
    s_barrier
    ds_read_b128 v[32:35], v21
    ds_read_b128 v[36:39], v21 offset:16
    ds_read2st64_b32 v[40:41], v20 offset0:0 offset1:1
    ds_read2st64_b32 v[42:43], v20 offset0:2 offset1:3
    ds_read2st64_b32 v[44:45], v20 offset0:4 offset1:5
    ds_read2st64_b32 v[46:47], v20 offset0:6 offset1:7
    s_waitcnt lgkmcnt(4)
    v_max3_f32 v48, v32, v33, v34
    v_max3_f32 v49, v36, v37, v38
    v_max3_f32 v48, v48, v35, v39
    v_max_f32 v48, v48, v49
    s_waitcnt lgkmcnt(0)
    v_pk_add_f32 v[40:41], v[40:41], v[42:43]
    v_pk_add_f32 v[44:45], v[44:45], v[46:47]
    v_pk_add_f32 v[40:41], v[40:41], v[44:45]
    v_add_f32 v40, v40, v41
    s_nop 1
    v_add_f32_dpp v40, v40, v40 row_ror:8 row_mask:0xf bank_mask:0xf
    s_nop 1
    v_add_f32_dpp v40, v40, v40 row_ror:4 row_mask:0xf bank_mask:0xf
    s_nop 1
    v_add_f32_dpp v40, v40, v40 row_ror:2 row_mask:0xf bank_mask:0xf
    s_nop 1
    v_add_f32_dpp v40, v40, v40 row_ror:1 row_mask:0xf bank_mask:0xf
    v_or_b32 v32, v2, v48
    v_and_or_b32 v33, v40, s46, v2
    v_mov_b32 v34, v32
    v_mov_b32 v35, v33
    s_mov_b32 exec_lo, 0x00010001
    s_mov_b32 exec_hi, 0x00010001
    s_cmp_eq_u32 s7, 1
    s_cbranch_scc0 S_9_s
    buffer_store_dwordx4 v[32:35], v22, s[8:11], s63 offen
S_9_e:
    s_mov_b64 exec, -1
    s_barrier
    ds_read2st64_b32 v[32:33], v19 offset0:0 offset1:1
    ds_read2st64_b32 v[34:35], v19 offset0:2 offset1:3
    ds_read2st64_b32 v[36:37], v19 offset0:4 offset1:5
    ds_read2st64_b32 v[38:39], v19 offset0:6 offset1:7
    s_waitcnt lgkmcnt(0)
    v_pk_add_f32 v[32:33], v[32:33], v[34:35]
    v_pk_add_f32 v[36:37], v[36:37], v[38:39]
    v_pk_add_f32 v[32:33], v[32:33], v[36:37]
    v_add_f32 v32, v32, v33
    v_and_or_b32 v32, v32, s46, v2
    buffer_store_dword v32, v17, s[8:11], s55 offen sc1
    s_add_u32 s42, s55, 8192
    buffer_store_dword v32, v17, s[8:11], s42 offen sc1
    s_endpgm
P_8_t:
    s_waitcnt vmcnt(0)
    s_branch P_8_x
S_9_s:
    buffer_store_dwordx4 v[32:35], v22, s[8:11], s63 offen sc1
    s_branch S_9_e
L_A:
    v_xor_b32 v6, v4, v3
    v_lshlrev_b32 v6, 4, v6
    v_lshl_add_u32 v6, v3, 8, v6
    v_add_u32 v6, s41, v6
    v_xor_b32 v8, 0, v6
    v_xor_b32 v9, 64, v6
    v_xor_b32 v10, 128, v6
    v_xor_b32 v11, 192, v6
    v_and_b32 v7, 3, v1
    v_mul_u32_u24 v12, 272, v7
    v_lshl_add_u32 v12, v4, 4, v12
    v_add_u32 v12, 131072, v12
    v_lshlrev_b32 v13, 5, v7
    v_add_u32 v13, 132224, v13
    s_lshl_b32 s42, s3, 2
    v_add_u32 v14, s42, v13
    v_lshlrev_b32 v16, 6, v4
    v_add_u32 v16, 134400, v16
    v_lshl_add_u32 v15, v3, 4, v16
    s_lshl_b32 s42, s3, 8
    v_add_u32 v15, s42, v15
    v_lshrrev_b32 v5, 2, v3
    v_lshl_add_u32 v16, v5, 4, v16
    v_lshrrev_b32 v6, 2, v1
    v_and_b32 v17, 7, v6
    v_lshlrev_b32 v17, 1, v17
    v_bfe_u32 v18, v1, 1, 1
    s_lshl_b32 s42, s3, 1
    v_add_u32 v21, s42, v18
    v_xor_b32 v17, v17, v21
    v_lshlrev_b32 v17, 4, v17
    v_lshl_add_u32 v17, v6, 8, v17
    v_and_b32 v21, 1, v1
    v_lshl_add_u32 v17, v21, 3, v17
    v_add_u32 v17, 65536, v17
    v_bfe_u32 v18, v1, 1, 1
    v_bfe_u32 v28, v1, 3, 1
    v_and_b32 v29, 1, v4
    v_lshl_add_u32 v28, v29, 1, v28
    v_lshlrev_b32 v28, 1, v28
    v_xor_b32 v28, v28, v18
    v_lshlrev_b32 v28, 4, v28
    v_and_b32 v29, 1, v1
    v_lshl_add_u32 v28, v29, 3, v28
    v_lshl_add_u32 v28, v5, 7, v28
    v_lshl_add_u32 v28, v4, 10, v28
    v_add_u32 v28, s41, v28
    v_xor_b32 v96, 0, v28
    v_xor_b32 v97, 32, v28
    v_xor_b32 v98, 64, v28
    v_xor_b32 v99, 96, v28
    v_lshlrev_b32 v100, 4, v1
    v_lshlrev_b32 v101, 4, v3
    v_lshlrev_b32 v102, 2, v3
    s_lshl_b32 s42, s3, 8
    s_add_u32 s42, s42, 136704
    v_add_u32 v102, s42, v102
    s_and_b32 s42, s5, 1
    s_lshl_b32 s42, s42, 3
    s_add_u32 s42, s42, s3
    s_lshl_b32 s48, s4, 4
    s_add_u32 s48, s48, s42
    s_lshl_b32 s48, s48, 11
    s_add_u32 s48, s48, 2883584
    s_lshr_b32 s42, s42, 2
    s_lshl_b32 s49, s4, 2
    s_add_u32 s49, s49, s42
    s_lshl_b32 s49, s49, 8
    s_add_u32 s49, s49, 2211840
    s_and_b32 s42, s3, 1
    s_lshl_b32 s42, s42, 9
    v_bfe_u32 v6, v3, 2, 1
    v_lshlrev_b32 v19, 10, v6
    v_lshrrev_b32 v6, 3, v3
    v_lshl_add_u32 v19, v6, 8, v19
    v_lshl_add_u32 v19, v7, 2, v19
    v_lshl_add_u32 v19, v4, 13, v19
    v_add_u32 v19, s42, v19
    s_lshl_b32 s54, s4, 4
    s_lshr_b32 s42, s3, 1
    s_add_u32 s54, s54, s42
    s_lshl_b32 s54, s54, 11
    s_lshl_b32 s42, s5, 4
    s_add_u32 s54, s54, s42
    s_add_u32 s54, s54, 2883584
    v_lshrrev_b32 v6, 5, v1
    v_and_b32 v20, 31, v1
    v_lshlrev_b32 v20, 2, v20
    v_lshl_add_u32 v20, v6, 11, v20
    s_lshl_b32 s55, s4, 3
    s_add_u32 s55, s55, s3
    s_lshl_b32 s55, s55, 12
    s_lshl_b32 s42, s5, 7
    s_add_u32 s55, s55, s42
    s_add_u32 s55, s55, 3145728
    v_mov_b32 v22, 136576
    v_lshlrev_b32 v21, 5, v4
    v_add_u32 v21, 132224, v21
    s_load_dwordx2 s[20:21], s[0:1], 32
    v_and_b32 v6, 7, v1
    v_bfe_u32 v28, v1, 4, 1
    v_lshlrev_b32 v28, 1, v28
    v_xor_b32 v6, v6, v28
    v_lshlrev_b32 v6, 4, v6
    v_lshrrev_b32 v28, 3, v1
    v_lshl_add_u32 v108, v28, 10, v6
    v_xor_b32 v109, 64, v108
    s_lshl_b32 s58, s4, 1
    s_and_b32 s42, s5, 1
    s_add_u32 s58, s58, s42
    s_lshl_b32 s58, s58, 3
    s_add_u32 s58, s58, s3
    s_lshl_b32 s58, s58, 15
    s_lshr_b32 s42, s5, 1
    s_lshl_b32 s42, s42, 7
    s_add_u32 s58, s58, s42
    s_mov_b32 s59, s41
    s_waitcnt lgkmcnt(0)
    v_mul_u32_u24 v12, 272, v5
    v_lshl_add_u32 v12, v4, 4, v12
    v_add_u32 v12, 131072, v12
    s_lshl_b32 s42, s3, 2
    v_add_u32 v14, s42, v21
    v_lshlrev_b32 v15, 6, v5
    v_lshl_add_u32 v15, v4, 4, v15
    v_lshl_add_u32 v15, v7, 1, v15
    s_lshl_b32 s42, s3, 8
    s_add_u32 s43, s42, 134400
    v_add_u32 v15, s43, v15
    v_lshlrev_b32 v110, 2, v1
    s_add_u32 s43, s42, 132352
    v_add_u32 v110, s43, v110
    s_mov_b32 s56, 0x3db504f3
    s_mov_b32 s57, 0x3fb8aa3b
    s_waitcnt lgkmcnt(0)
    s_add_u32 s45, s45, 1
    s_and_b32 s6, s45, 1023
    v_mov_b32 v2, s6
    s_waitcnt vmcnt(8)
    ds_read_b128 v[32:35], v8 offset:0
    ds_read_b128 v[36:39], v9 offset:0
    ds_read_b128 v[40:43], v10 offset:0
    ds_read_b128 v[44:47], v11 offset:0
    ds_read_b128 v[48:51], v8 offset:4096
    ds_read_b128 v[52:55], v9 offset:4096
    ds_read_b128 v[56:59], v10 offset:4096
    ds_read_b128 v[60:63], v11 offset:4096
    s_waitcnt lgkmcnt(0)
    s_waitcnt vmcnt(0)
    s_barrier
    ds_read_b128 v[64:67], v12 offset:0
    ds_read_b128 v[68:71], v12 offset:64
    ds_read_b128 v[72:75], v12 offset:128
    ds_read_b128 v[76:79], v12 offset:192
    s_mov_b32 m0, s59
    s_nop 0
    buffer_load_dwordx4 v108, s[20:23], s58 offen offset:0 lds
    s_add_u32 s58, s58, 7168
    buffer_load_dwordx4 v109, s[20:23], s58 offen offset:1024 lds
    s_add_u32 s58, s58, 7168
    buffer_load_dwordx4 v108, s[20:23], s58 offen offset:2048 lds
    s_add_u32 s58, s58, 7168
    buffer_load_dwordx4 v109, s[20:23], s58 offen offset:3072 lds
    s_waitcnt lgkmcnt(3)
    v_mfma_f32_16x16x32_bf16 v[24:27], v[64:67], v[32:35], 0
    v_mfma_f32_16x16x32_bf16 v[28:31], v[64:67], v[48:51], 0
    s_waitcnt lgkmcnt(2)
    v_mfma_f32_16x16x32_bf16 v[24:27], v[68:71], v[36:39], v[24:27]
    v_mfma_f32_16x16x32_bf16 v[28:31], v[68:71], v[52:55], v[28:31]
    s_waitcnt lgkmcnt(1)
    v_mfma_f32_16x16x32_bf16 v[24:27], v[72:75], v[40:43], v[24:27]
    v_mfma_f32_16x16x32_bf16 v[28:31], v[72:75], v[56:59], v[28:31]
    s_waitcnt lgkmcnt(0)
    v_mfma_f32_16x16x32_bf16 v[24:27], v[76:79], v[44:47], v[24:27]
    v_mfma_f32_16x16x32_bf16 v[28:31], v[76:79], v[60:63], v[28:31]
    ds_read_b64_tr_b16 v[64:65], v17 offset:0
    ds_read_b64_tr_b16 v[66:67], v17 offset:4096
    ds_read_b64_tr_b16 v[68:69], v17 offset:8192
    ds_read_b64_tr_b16 v[70:71], v17 offset:12288
    ds_read_b64_tr_b16 v[72:73], v17 offset:16384
    ds_read_b64_tr_b16 v[74:75], v17 offset:20480
    ds_read_b64_tr_b16 v[76:77], v17 offset:24576
    ds_read_b64_tr_b16 v[78:79], v17 offset:28672
    ds_read_b64_tr_b16 v[80:81], v17 offset:32768
    ds_read_b64_tr_b16 v[82:83], v17 offset:36864
    ds_read_b64_tr_b16 v[84:85], v17 offset:40960
    ds_read_b64_tr_b16 v[86:87], v17 offset:45056
    ds_read_b64_tr_b16 v[88:89], v17 offset:49152
    ds_read_b64_tr_b16 v[90:91], v17 offset:53248
    ds_read_b64_tr_b16 v[92:93], v17 offset:57344
    ds_read_b64_tr_b16 v[94:95], v17 offset:61440
    v_cvt_pk_bf16_f32 v24, 0, v24
    v_cvt_pk_bf16_f32 v25, 0, v28
    v_pk_mul_f32 v[24:25], v[24:25], s[56:57] op_sel_hi:[1,0]
    v_cvt_pk_bf16_f32 v24, 0, v24
    v_cvt_pk_bf16_f32 v25, 0, v25
    v_max_f32 v32, v24, v25
    s_nop 1
    v_max_f32_dpp v32, v32, v32 row_ror:8 row_mask:0xf bank_mask:0xf
    s_nop 1
    v_max_f32_dpp v32, v32, v32 row_ror:4 row_mask:0xf bank_mask:0xf
    s_nop 1
    v_max_f32_dpp v32, v32, v32 row_ror:2 row_mask:0xf bank_mask:0xf
    s_nop 1
    v_max_f32_dpp v32, v32, v32 row_ror:1 row_mask:0xf bank_mask:0xf
    s_mov_b32 exec_lo, 0x00010001
    s_mov_b32 exec_hi, 0x00010001
    ds_write_b32 v14, v32
    s_mov_b64 exec, -1
    s_waitcnt lgkmcnt(0)
    s_barrier
    ds_read_b128 v[32:35], v21
    ds_read_b128 v[36:39], v21 offset:16
    s_waitcnt lgkmcnt(0)
    v_max3_f32 v32, v32, v33, v34
    v_max3_f32 v36, v36, v37, v38
    v_max3_f32 v32, v32, v35, v39
    v_max_f32 v32, v32, v36
    v_pk_add_f32 v[24:25], v[24:25], v[32:33] op_sel_hi:[1,0] neg_lo:[0,1] neg_hi:[0,1]
    v_pk_mul_f32 v[24:25], v[24:25], s[56:57] op_sel:[0,1] op_sel_hi:[1,1]
    v_exp_f32 v24, v24
    v_exp_f32 v25, v25
    s_nop 0
    v_cvt_pk_bf16_f32 v36, v24, v25
    v_add_f32 v24, v24, v25
    ds_write_b16 v15, v36
    ds_write_b16_d16_hi v15, v36 offset:8
    ds_write_b32 v110, v24
    s_waitcnt lgkmcnt(0)
    s_barrier
    ds_read_b32 v23, v22
    ds_read_b128 v[32:35], v16 offset:0
    ds_read_b128 v[36:39], v16 offset:256
    ds_read_b128 v[40:43], v16 offset:512
    ds_read_b128 v[44:47], v16 offset:768
    ds_read_b128 v[48:51], v16 offset:1024
    ds_read_b128 v[52:55], v16 offset:1280
    ds_read_b128 v[56:59], v16 offset:1536
    ds_read_b128 v[60:63], v16 offset:1792
    s_waitcnt lgkmcnt(7)
    v_mfma_f32_16x16x32_bf16 v[24:27], v[32:35], v[64:67], 0
    s_waitcnt lgkmcnt(6)
    v_readfirstlane_b32 s7, v23
    v_mfma_f32_16x16x32_bf16 v[28:31], v[36:39], v[68:71], 0
    s_waitcnt lgkmcnt(5)
    v_mfma_f32_16x16x32_bf16 v[24:27], v[40:43], v[72:75], v[24:27]
    s_waitcnt lgkmcnt(4)
    v_mfma_f32_16x16x32_bf16 v[28:31], v[44:47], v[76:79], v[28:31]
    s_waitcnt lgkmcnt(3)
    v_mfma_f32_16x16x32_bf16 v[24:27], v[48:51], v[80:83], v[24:27]
    s_waitcnt lgkmcnt(2)
    v_mfma_f32_16x16x32_bf16 v[28:31], v[52:55], v[84:87], v[28:31]
    s_waitcnt lgkmcnt(1)
    v_mfma_f32_16x16x32_bf16 v[24:27], v[56:59], v[88:91], v[24:27]
    s_waitcnt lgkmcnt(0)
    v_mfma_f32_16x16x32_bf16 v[28:31], v[60:63], v[92:95], v[28:31]
    s_nop 7
    v_add_f32 v24, v24, v28
    v_and_or_b32 v28, v24, s46, v2
    s_cmp_eq_u32 s7, 1
    s_cbranch_scc0 S_10_s
    buffer_store_dword v28, v19, s[8:11], s54 offen
S_10_e:
    s_mov_b32 s47, 0
P_11:
    buffer_load_dwordx4 v[56:59], v101, s[8:11], s49 offen sc1
    s_add_u32 s47, s47, 1
    s_cmp_gt_u32 s47, 1000000
    s_cbranch_scc1 P_11_t
    s_waitcnt vmcnt(0)
    v_xor_b32 v56, v2, v56
    v_xor_b32 v57, v2, v57
    v_xor_b32 v58, v2, v58
    v_xor_b32 v59, v2, v59
    v_or_b32 v30, v56, v57
    v_or3_b32 v30, v30, v58, v59
    v_and_b32 v30, 1023, v30
    v_cmp_ne_u32 vcc, 0, v30
    s_cbranch_vccnz P_11
P_11_x:
    buffer_load_dwordx4 v[48:51], v100, s[8:11], s48 offen sc1
    buffer_load_dwordx4 v[52:55], v100, s[8:11], s48 offen offset:1024 sc1
    ds_read_b64_tr_b16 v[64:65], v96
    ds_read_b64_tr_b16 v[66:67], v96 offset:512
    ds_read_b64_tr_b16 v[68:69], v97
    ds_read_b64_tr_b16 v[70:71], v97 offset:512
    ds_read_b64_tr_b16 v[72:73], v98
    ds_read_b64_tr_b16 v[74:75], v98 offset:512
    ds_read_b64_tr_b16 v[76:77], v99
    ds_read_b64_tr_b16 v[78:79], v99 offset:512
    v_max_f32_dpp v58, v56, v56 row_ror:8 row_mask:0xf bank_mask:0xf
    s_nop 1
    v_max_f32_dpp v58, v58, v58 row_ror:4 row_mask:0xf bank_mask:0xf
    s_nop 1
    v_max_f32_dpp v58, v58, v58 row_ror:2 row_mask:0xf bank_mask:0xf
    s_nop 1
    v_max_f32_dpp v58, v58, v58 row_ror:1 row_mask:0xf bank_mask:0xf
    v_sub_f32 v56, v56, v58
    v_mul_f32 v56, s57, v56
    v_exp_f32 v56, v56
    s_nop 0
    v_mul_f32 v57, v56, v57
    s_nop 1
    v_add_f32_dpp v57, v57, v57 row_ror:8 row_mask:0xf bank_mask:0xf
    s_nop 1
    v_add_f32_dpp v57, v57, v57 row_ror:4 row_mask:0xf bank_mask:0xf
    s_nop 1
    v_add_f32_dpp v57, v57, v57 row_ror:2 row_mask:0xf bank_mask:0xf
    s_nop 1
    v_add_f32_dpp v57, v57, v57 row_ror:1 row_mask:0xf bank_mask:0xf
    v_rcp_f32 v57, v57
    s_nop 0
    v_mul_f32 v56, v56, v57
    s_mov_b32 s47, 0
    s_branch P_12_w
P_12:
    buffer_load_dwordx4 v[48:51], v100, s[8:11], s48 offen sc1
    buffer_load_dwordx4 v[52:55], v100, s[8:11], s48 offen offset:1024 sc1
P_12_w:
    s_add_u32 s47, s47, 1
    s_cmp_gt_u32 s47, 1000000
    s_cbranch_scc1 P_12_t
    s_waitcnt vmcnt(0)
    v_xor_b32 v48, v2, v48
    v_xor_b32 v49, v2, v49
    v_xor_b32 v50, v2, v50
    v_xor_b32 v51, v2, v51
    v_xor_b32 v52, v2, v52
    v_xor_b32 v53, v2, v53
    v_xor_b32 v54, v2, v54
    v_xor_b32 v55, v2, v55
    v_or_b32 v30, v48, v49
    v_or3_b32 v30, v30, v50, v51
    v_or3_b32 v30, v30, v52, v53
    v_or3_b32 v30, v30, v54, v55
    v_and_b32 v30, 1023, v30
    v_cmp_ne_u32 vcc, 0, v30
    s_cbranch_vccnz P_12
P_12_x:
    v_pk_mul_f32 v[48:49], v[48:49], v[56:57] op_sel_hi:[1,0]
    v_pk_mul_f32 v[50:51], v[50:51], v[56:57] op_sel_hi:[1,0]
    v_pk_mul_f32 v[52:53], v[52:53], v[56:57] op_sel_hi:[1,0]
    v_pk_mul_f32 v[54:55], v[54:55], v[56:57] op_sel_hi:[1,0]
    v_add_f32_dpp v48, v48, v48 row_ror:8 row_mask:0xf bank_mask:0xf
    v_add_f32_dpp v49, v49, v49 row_ror:8 row_mask:0xf bank_mask:0xf
    v_add_f32_dpp v50, v50, v50 row_ror:8 row_mask:0xf bank_mask:0xf
    v_add_f32_dpp v51, v51, v51 row_ror:8 row_mask:0xf bank_mask:0xf
    v_add_f32_dpp v52, v52, v52 row_ror:8 row_mask:0xf bank_mask:0xf
    v_add_f32_dpp v53, v53, v53 row_ror:8 row_mask:0xf bank_mask:0xf
    v_add_f32_dpp v54, v54, v54 row_ror:8 row_mask:0xf bank_mask:0xf
    v_add_f32_dpp v55, v55, v55 row_ror:8 row_mask:0xf bank_mask:0xf
    v_add_f32_dpp v48, v48, v48 row_ror:4 row_mask:0xf bank_mask:0xf
    v_add_f32_dpp v49, v49, v49 row_ror:4 row_mask:0xf bank_mask:0xf
    v_add_f32_dpp v50, v50, v50 row_ror:4 row_mask:0xf bank_mask:0xf
    v_add_f32_dpp v51, v51, v51 row_ror:4 row_mask:0xf bank_mask:0xf
    v_add_f32_dpp v52, v52, v52 row_ror:4 row_mask:0xf bank_mask:0xf
    v_add_f32_dpp v53, v53, v53 row_ror:4 row_mask:0xf bank_mask:0xf
    v_add_f32_dpp v54, v54, v54 row_ror:4 row_mask:0xf bank_mask:0xf
    v_add_f32_dpp v55, v55, v55 row_ror:4 row_mask:0xf bank_mask:0xf
    v_add_f32_dpp v48, v48, v48 row_ror:2 row_mask:0xf bank_mask:0xf
    v_add_f32_dpp v49, v49, v49 row_ror:2 row_mask:0xf bank_mask:0xf
    v_add_f32_dpp v50, v50, v50 row_ror:2 row_mask:0xf bank_mask:0xf
    v_add_f32_dpp v51, v51, v51 row_ror:2 row_mask:0xf bank_mask:0xf
    v_add_f32_dpp v52, v52, v52 row_ror:2 row_mask:0xf bank_mask:0xf
    v_add_f32_dpp v53, v53, v53 row_ror:2 row_mask:0xf bank_mask:0xf
    v_add_f32_dpp v54, v54, v54 row_ror:2 row_mask:0xf bank_mask:0xf
    v_add_f32_dpp v55, v55, v55 row_ror:2 row_mask:0xf bank_mask:0xf
    v_add_f32_dpp v48, v48, v48 row_ror:1 row_mask:0xf bank_mask:0xf
    v_add_f32_dpp v49, v49, v49 row_ror:1 row_mask:0xf bank_mask:0xf
    v_add_f32_dpp v50, v50, v50 row_ror:1 row_mask:0xf bank_mask:0xf
    v_add_f32_dpp v51, v51, v51 row_ror:1 row_mask:0xf bank_mask:0xf
    v_add_f32_dpp v52, v52, v52 row_ror:1 row_mask:0xf bank_mask:0xf
    v_add_f32_dpp v53, v53, v53 row_ror:1 row_mask:0xf bank_mask:0xf
    v_add_f32_dpp v54, v54, v54 row_ror:1 row_mask:0xf bank_mask:0xf
    v_add_f32_dpp v55, v55, v55 row_ror:1 row_mask:0xf bank_mask:0xf
    v_cvt_pk_bf16_f32 v32, v48, v49
    v_cvt_pk_bf16_f32 v33, v50, v51
    v_cvt_pk_bf16_f32 v34, v52, v53
    v_cvt_pk_bf16_f32 v35, v54, v55
    s_waitcnt lgkmcnt(0)
    s_nop 0
    v_mfma_f32_16x16x32_bf16 v[36:39], v[32:35], v[64:67], 0
    v_mfma_f32_16x16x32_bf16 v[40:43], v[32:35], v[68:71], 0
    v_mfma_f32_16x16x32_bf16 v[44:47], v[32:35], v[72:75], 0
    v_mfma_f32_16x16x32_bf16 v[48:51], v[32:35], v[76:79], 0
    s_mov_b64 exec, 0xffff
    s_nop 4
    ds_write2_b32 v102, v36, v40 offset1:16
    s_nop 0
    ds_write2_b32 v102, v44, v48 offset0:32 offset1:48
    s_waitcnt lgkmcnt(0)
    s_barrier
    s_endpgm
S_10_s:
    buffer_store_dword v28, v19, s[8:11], s54 offen sc1
    s_branch S_10_e
P_11_t:
    s_waitcnt vmcnt(0)
    s_branch P_11_x
P_12_t:
    s_waitcnt vmcnt(0)
    s_branch P_12_x
L_M2:
    s_mul_i32 s59, s4, 7
    s_add_u32 s59, s59, s58
    s_cmp_eq_u32 s58, 7
    s_cbranch_scc1 L_R
    v_mul_u32_u24 v5, 28672, v4
    v_lshl_add_u32 v5, v3, 2, v5
    s_and_b32 s42, s59, 1
    s_cselect_b32 s44, 139776, 0
    s_cselect_b32 s48, -1, 1
    s_cselect_b32 s63, 78, 0
    s_cselect_b32 s42, 7, 0
    s_xor_b32 s3, s3, s42
    s_mul_i32 s49, s48, 89600
    s_mul_i32 s48, s48, 3584
    s_mul_i32 s41, s3, 229376
    s_lshl_b32 s42, s59, 6
    s_add_u32 s41, s41, s42
    s_add_u32 s41, s41, s44
    s_lshl_b32 s40, s3, 7
    s_barrier
    buffer_load_ushort v8, v7, s[24:27], s40 offen
    buffer_load_dword v32, v5, s[28:31], s41 offen
    buffer_load_dword v48, v5, s[32:35], s41 offen
    s_add_u32 s41, s41, s48
    buffer_load_dword v33, v5, s[28:31], s41 offen
    buffer_load_dword v49, v5, s[32:35], s41 offen
    s_add_u32 s41, s41, s48
    buffer_load_dword v34, v5, s[28:31], s41 offen
    buffer_load_dword v50, v5, s[32:35], s41 offen
    s_add_u32 s41, s41, s48
    buffer_load_dword v35, v5, s[28:31], s41 offen
    buffer_load_dword v51, v5, s[32:35], s41 offen
    s_add_u32 s41, s41, s48
    buffer_load_dword v36, v5, s[28:31], s41 offen
    buffer_load_dword v52, v5, s[32:35], s41 offen
    s_add_u32 s41, s41, s48
    buffer_load_dword v37, v5, s[28:31], s41 offen
    buffer_load_dword v53, v5, s[32:35], s41 offen
    s_add_u32 s41, s41, s48
    buffer_load_dword v38, v5, s[28:31], s41 offen
    buffer_load_dword v54, v5, s[32:35], s41 offen
    s_add_u32 s41, s41, s48
    buffer_load_dword v39, v5, s[28:31], s41 offen
    buffer_load_dword v55, v5, s[32:35], s41 offen
    s_add_u32 s41, s41, s49
    buffer_load_dword v40, v5, s[28:31], s41 offen
    buffer_load_dword v56, v5, s[32:35], s41 offen
    s_add_u32 s41, s41, s48
    buffer_load_dword v41, v5, s[28:31], s41 offen
    buffer_load_dword v57, v5, s[32:35], s41 offen
    s_add_u32 s41, s41, s48
    buffer_load_dword v42, v5, s[28:31], s41 offen
    buffer_load_dword v58, v5, s[32:35], s41 offen
    s_add_u32 s41, s41, s48
    buffer_load_dword v43, v5, s[28:31], s41 offen
    buffer_load_dword v59, v5, s[32:35], s41 offen
    s_add_u32 s41, s41, s48
    buffer_load_dword v44, v5, s[28:31], s41 offen
    buffer_load_dword v60, v5, s[32:35], s41 offen
    s_add_u32 s41, s41, s48
    buffer_load_dword v45, v5, s[28:31], s41 offen
    buffer_load_dword v61, v5, s[32:35], s41 offen
    s_add_u32 s41, s41, s48
    buffer_load_dword v46, v5, s[28:31], s41 offen
    buffer_load_dword v62, v5, s[32:35], s41 offen
    s_add_u32 s41, s41, s48
    buffer_load_dword v47, v5, s[28:31], s41 offen
    buffer_load_dword v63, v5, s[32:35], s41 offen
    v_lshlrev_b32 v6, 13, v4
    v_lshl_add_u32 v6, v3, 3, v6
    s_lshl_b32 s43, s59, 15
    s_add_u32 s43, s43, s40
    s_add_u32 s41, s43, 4096
    buffer_load_dwordx2 v[64:65], v6, s[36:39], s43 offen offset:0
    buffer_load_dwordx2 v[66:67], v6, s[36:39], s43 offen offset:1024
    buffer_load_dwordx2 v[68:69], v6, s[36:39], s43 offen offset:2048
    buffer_load_dwordx2 v[70:71], v6, s[36:39], s43 offen offset:3072
    buffer_load_dwordx2 v[72:73], v6, s[36:39], s41 offen offset:0
    buffer_load_dwordx2 v[74:75], v6, s[36:39], s41 offen offset:1024
    buffer_load_dwordx2 v[76:77], v6, s[36:39], s41 offen offset:2048
    buffer_load_dwordx2 v[78:79], v6, s[36:39], s41 offen offset:3072
    s_lshl_b32 s42, s3, 8
    s_lshl_b32 s54, s3, 17
    s_add_u32 s54, s54, 4096
    s_mul_i32 s55, s4, 12288
    s_add_u32 s55, s55, s42
    s_add_u32 s55, s55, 2117632
    s_add_u32 s56, s55, 4096
    buffer_load_dword v112, v17, s[8:11], s55 offen sc1
    buffer_load_dword v113, v17, s[8:11], s55 offen offset:2048 sc1
    buffer_load_dword v114, v17, s[8:11], s56 offen sc1
    v_add_u32 v13, s42, v17
    v_add_u32 v13, 2048, v13
    s_lshl_b32 s43, s3, 3
    s_add_u32 s43, s43, 4096
    v_mov_b32 v14, s43
    v_and_b32 v15, 7, v1
    v_lshlrev_b32 v15, 3, v15
    v_add_u32 v15, 4096, v15
    s_add_u32 s43, s40, 4224
    v_xor_b32 v16, s63, v7
    v_add_u32 v16, s43, v16
    v_add_u32 v18, s43, v9
    s_add_u32 s43, s42, 5376
    v_lshlrev_b32 v19, 3, v3
    v_add_u32 v19, s43, v19
    s_lshl_b32 s43, s3, 6
    s_add_u32 s43, s43, 7424
    v_lshlrev_b32 v10, 1, v11
    v_add_u32 v10, s43, v10
    v_add_u32 v11, s43, v9
    v_lshrrev_b32 v12, 3, v3
    v_lshlrev_b32 v12, 9, v12
    v_and_b32 v20, 7, v3
    v_lshl_add_u32 v12, v20, 4, v12
    s_bfe_u32 s62, s59, 0x40001
    s_lshl_b32 s62, s62, 17
    s_lshr_b32 s42, s59, 5
    s_lshl_b32 s42, s42, 8
    s_add_u32 s62, s62, s42
    s_and_b32 s42, s59, 1
    s_lshl_b32 s42, s42, 7
    s_add_u32 s62, s62, s42
    s_lshl_b32 s42, s3, 10
    s_add_u32 s62, s62, s42
    s_add_u32 s62, s62, 16384
    v_mov_b32 v21, 1152
    s_waitcnt vmcnt(11)
    v_perm_b32 v80, v33, v32, s50
    v_perm_b32 v81, v35, v34, s50
    v_perm_b32 v82, v37, v36, s50
    v_perm_b32 v83, v39, v38, s50
    v_perm_b32 v84, v33, v32, s51
    v_perm_b32 v85, v35, v34, s51
    v_perm_b32 v86, v37, v36, s51
    v_perm_b32 v87, v39, v38, s51
    v_perm_b32 v88, v41, v40, s50
    v_perm_b32 v89, v43, v42, s50
    v_perm_b32 v90, v45, v44, s50
    v_perm_b32 v91, v47, v46, s50
    v_perm_b32 v92, v41, v40, s51
    v_perm_b32 v93, v43, v42, s51
    v_perm_b32 v94, v45, v44, s51
    v_perm_b32 v95, v47, v46, s51
    v_perm_b32 v96, v49, v48, s50
    v_perm_b32 v97, v51, v50, s50
    v_perm_b32 v98, v53, v52, s50
    v_perm_b32 v99, v55, v54, s50
    v_perm_b32 v100, v49, v48, s51
    v_perm_b32 v101, v51, v50, s51
    v_perm_b32 v102, v53, v52, s51
    v_perm_b32 v103, v55, v54, s51
    v_perm_b32 v104, v57, v56, s50
    v_perm_b32 v105, v59, v58, s50
    v_perm_b32 v106, v61, v60, s50
    v_perm_b32 v107, v63, v62, s50
    v_perm_b32 v108, v57, v56, s51
    v_perm_b32 v109, v59, v58, s51
    v_perm_b32 v110, v61, v60, s51
    v_perm_b32 v111, v63, v62, s51
    s_waitcnt vmcnt(3)
    v_perm_b32 v32, v66, v64, s50
    v_perm_b32 v33, v70, v68, s50
    v_perm_b32 v34, v74, v72, s50
    v_perm_b32 v35, v78, v76, s50
    v_perm_b32 v36, v66, v64, s51
    v_perm_b32 v37, v70, v68, s51
    v_perm_b32 v38, v74, v72, s51
    v_perm_b32 v39, v78, v76, s51
    v_perm_b32 v40, v67, v65, s50
    v_perm_b32 v41, v71, v69, s50
    v_perm_b32 v42, v75, v73, s50
    v_perm_b32 v43, v79, v77, s50
    v_perm_b32 v44, v67, v65, s51
    v_perm_b32 v45, v71, v69, s51
    v_perm_b32 v46, v75, v73, s51
    v_perm_b32 v47, v79, v77, s51
    v_lshlrev_b32 v8, 16, v8
    s_mov_b32 s47, 0
    s_branch P_13_w
P_13:
    buffer_load_dword v112, v17, s[8:11], s55 offen sc1
    buffer_load_dword v113, v17, s[8:11], s55 offen offset:2048 sc1
    buffer_load_dword v114, v17, s[8:11], s56 offen sc1
P_13_w:
    s_add_u32 s47, s47, 1
    s_cmp_gt_u32 s47, 1000000
    s_cbranch_scc1 P_13_t
    s_waitcnt vmcnt(0)
    v_xor_b32 v112, v2, v112
    v_xor_b32 v113, v2, v113
    v_xor_b32 v114, v2, v114
    v_or_b32 v30, v112, v113
    v_or_b32 v30, v30, v114
    v_and_b32 v30, 1023, v30
    v_cmp_ne_u32 vcc, 0, v30
    s_cbranch_vccnz P_13
P_13_x:
    ds_read_b32 v21, v21
    v_add_f32 v114, 1.0, v114
    v_cvt_pk_bf16_f32 v114, 0, v114
    s_waitcnt lgkmcnt(0)
    v_readfirstlane_b32 s76, v21
    s_mov_b32 s63, 0x42800000
    s_nop 2
    s_add_u32 s54, s54, s76
    s_add_u32 s40, s54, 1048576
    s_mov_b32 s47, 0
P_14:
    buffer_load_dword v48, v17, s[8:11], s54 offen offset:0 sc1
    buffer_load_dword v49, v17, s[8:11], s40 offen offset:0 sc1
    buffer_load_dword v50, v17, s[8:11], s54 offen offset:256 sc1
    buffer_load_dword v51, v17, s[8:11], s40 offen offset:256 sc1
    buffer_load_dword v52, v17, s[8:11], s54 offen offset:512 sc1
    buffer_load_dword v53, v17, s[8:11], s40 offen offset:512 sc1
    buffer_load_dword v54, v17, s[8:11], s54 offen offset:768 sc1
    buffer_load_dword v55, v17, s[8:11], s40 offen offset:768 sc1
    buffer_load_dword v60, v17, s[8:11], s54 offen offset:1024 sc1
    buffer_load_dword v61, v17, s[8:11], s40 offen offset:1024 sc1
    buffer_load_dword v62, v17, s[8:11], s54 offen offset:1280 sc1
    buffer_load_dword v63, v17, s[8:11], s40 offen offset:1280 sc1
    buffer_load_dword v64, v17, s[8:11], s54 offen offset:1536 sc1
    buffer_load_dword v65, v17, s[8:11], s40 offen offset:1536 sc1
    buffer_load_dword v66, v17, s[8:11], s54 offen offset:1792 sc1
    buffer_load_dword v67, v17, s[8:11], s40 offen offset:1792 sc1
    s_add_u32 s47, s47, 1
    s_cmp_gt_u32 s47, 1000000
    s_cbranch_scc1 P_14_t
    s_waitcnt vmcnt(12)
    v_xor_b32 v48, v2, v48
    v_xor_b32 v49, v2, v49
    v_xor_b32 v50, v2, v50
    v_xor_b32 v51, v2, v51
    v_or_b32 v30, v48, v49
    v_pk_add_f32 v[68:69], v[48:49], v[50:51]
    v_or3_b32 v30, v30, v50, v51
    s_waitcnt vmcnt(8)
    v_xor_b32 v52, v2, v52
    v_xor_b32 v53, v2, v53
    v_xor_b32 v54, v2, v54
    v_xor_b32 v55, v2, v55
    v_or3_b32 v30, v30, v52, v53
    v_or3_b32 v30, v30, v54, v55
    v_pk_add_f32 v[52:53], v[52:53], v[54:55]
    v_pk_add_f32 v[68:69], v[68:69], v[52:53]
    s_waitcnt vmcnt(4)
    v_xor_b32 v60, v2, v60
    v_xor_b32 v61, v2, v61
    v_xor_b32 v62, v2, v62
    v_xor_b32 v63, v2, v63
    v_or3_b32 v30, v30, v60, v61
    v_or3_b32 v30, v30, v62, v63
    v_pk_add_f32 v[60:61], v[60:61], v[62:63]
    v_pk_add_f32 v[68:69], v[68:69], v[60:61]
    s_waitcnt vmcnt(0)
    v_xor_b32 v64, v2, v64
    v_xor_b32 v65, v2, v65
    v_xor_b32 v66, v2, v66
    v_xor_b32 v67, v2, v67
    v_or3_b32 v30, v30, v64, v65
    v_or3_b32 v30, v30, v66, v67
    v_and_b32 v30, 1023, v30
    v_cmp_ne_u32 vcc, 0, v30
    v_pk_add_f32 v[64:65], v[64:65], v[66:67]
    v_pk_add_f32 v[68:69], v[68:69], v[64:65]
    s_cbranch_vccnz P_14
P_14_x:
    v_add_f32 v48, v68, v69
    v_cvt_pk_bf16_f32 v48, 0, v48
    v_mul_f32 v48, v112, v48
    v_cvt_pk_bf16_f32 v48, 0, v48
    v_add_f32 v48, v8, v48
    v_cvt_pk_bf16_f32 v48, 0, v48
    ds_write_b32 v13, v48
    v_readfirstlane_b32 s40, v48
    s_nop 1
    v_subrev_f32 v49, s40, v48
    v_mul_f32 v50, v49, v49
    s_nop 0
    v_add_f32_dpp v49, v49, v49 row_shr:1 row_mask:0xf bank_mask:0xf bound_ctrl:0
    v_add_f32_dpp v50, v50, v50 row_shr:1 row_mask:0xf bank_mask:0xf bound_ctrl:0
    s_nop 0
    v_add_f32_dpp v49, v49, v49 row_shr:2 row_mask:0xf bank_mask:0xf bound_ctrl:0
    v_add_f32_dpp v50, v50, v50 row_shr:2 row_mask:0xf bank_mask:0xf bound_ctrl:0
    s_nop 0
    v_add_f32_dpp v49, v49, v49 row_shr:4 row_mask:0xf bank_mask:0xf bound_ctrl:0
    v_add_f32_dpp v50, v50, v50 row_shr:4 row_mask:0xf bank_mask:0xf bound_ctrl:0
    s_nop 0
    v_add_f32_dpp v49, v49, v49 row_shr:8 row_mask:0xf bank_mask:0xf bound_ctrl:0
    v_add_f32_dpp v50, v50, v50 row_shr:8 row_mask:0xf bank_mask:0xf bound_ctrl:0
    s_nop 0
    v_add_f32_dpp v49, v49, v49 row_bcast:15 row_mask:0xa bank_mask:0xf
    v_add_f32_dpp v50, v50, v50 row_bcast:15 row_mask:0xa bank_mask:0xf
    s_nop 0
    v_add_f32_dpp v49, v49, v49 row_bcast:31 row_mask:0xc bank_mask:0xf
    v_add_f32_dpp v50, v50, v50 row_bcast:31 row_mask:0xc bank_mask:0xf
    v_mul_f32 v51, 0x3c800000, v49
    s_mov_b32 exec_lo, 0
    v_fma_f32 v53, -v51, v49, v50
    v_add_f32 v52, s40, v51
    s_mov_b32 exec_hi, 0x80000000
    ds_write_b64 v14, v[52:53]
    s_mov_b64 exec, -1
    s_waitcnt lgkmcnt(0)
    s_barrier
    ds_read_b64 v[60:61], v15
    s_waitcnt lgkmcnt(0)
    v_add_f32_dpp v49, v60, v60 row_ror:4 row_mask:0xf bank_mask:0xf
    s_nop 1
    v_add_f32_dpp v49, v49, v49 row_ror:2 row_mask:0xf bank_mask:0xf
    s_nop 1
    v_add_f32_dpp v49, v49, v49 row_ror:1 row_mask:0xf bank_mask:0xf
    v_mul_f32 v49, 0x3e000000, v49
    v_sub_f32 v60, v60, v49
    v_mul_f32 v60, v60, v60
    v_fma_f32 v61, v60, s63, v61
    v_cvt_pk_bf16_f32 v49, 0, v49
    v_sub_f32 v48, v48, v49
    v_add_f32_dpp v61, v61, v61 row_ror:4 row_mask:0xf bank_mask:0xf
    v_cvt_pk_bf16_f32 v48, 0, v48
    s_nop 0
    v_add_f32_dpp v61, v61, v61 row_ror:2 row_mask:0xf bank_mask:0xf
    s_nop 1
    v_add_f32_dpp v61, v61, v61 row_ror:1 row_mask:0xf bank_mask:0xf
    v_mul_f32 v61, 0x3b000000, v61
    v_cvt_pk_bf16_f32 v61, 0, v61
    v_add_f32 v61, 0x3727c5ac, v61
    v_cvt_pk_bf16_f32 v61, 0, v61
    v_sqrt_f32 v61, v61
    s_nop 0
    v_cvt_pk_bf16_f32 v61, 0, v61
    v_rcp_f32 v62, v61
    s_nop 0
    v_mul_f32 v63, v48, v62
    v_fma_f32 v61, -v63, v61, v48
    v_fma_f32 v61, v61, v62, v63
    v_cvt_pk_bf16_f32 v48, 0, v61
    v_mul_f32 v48, v48, v114
    v_cvt_pk_bf16_f32 v48, 0, v48
    v_add_f32 v48, v48, v113
    v_cvt_pk_bf16_f32 v48, 0, v48
    ds_write_b16_d16_hi v16, v48
    ds_read_b128 v[20:23], v18
    ds_read_b128 v[24:27], v18 offset:64
    s_waitcnt lgkmcnt(1)
    v_mfma_f32_16x16x32_bf16 v[48:51], v[20:23], v[80:83], 0
    v_mfma_f32_16x16x32_bf16 v[52:55], v[20:23], v[84:87], 0
    v_mfma_f32_16x16x32_bf16 v[56:59], v[20:23], v[96:99], 0
    v_mfma_f32_16x16x32_bf16 v[60:63], v[20:23], v[100:103], 0
    s_waitcnt lgkmcnt(0)
    v_mfma_f32_16x16x32_bf16 v[48:51], v[24:27], v[88:91], v[48:51]
    v_mfma_f32_16x16x32_bf16 v[52:55], v[24:27], v[92:95], v[52:55]
    v_mfma_f32_16x16x32_bf16 v[56:59], v[24:27], v[104:107], v[56:59]
    v_mfma_f32_16x16x32_bf16 v[60:63], v[24:27], v[108:111], v[60:63]
    s_mov_b64 exec, 0xffff
    s_nop 4
    ds_write2_b32 v19, v48, v52 offset1:1
    s_nop 0
    ds_write2_b32 v19, v56, v60 offset0:32 offset1:33
    s_mov_b64 exec, -1
    s_waitcnt lgkmcnt(0)
    s_barrier
    ds_read2st64_b32 v[48:49], v17 offset0:21 offset1:22
    ds_read2st64_b32 v[50:51], v17 offset0:23 offset1:24
    ds_read2st64_b32 v[52:53], v17 offset0:25 offset1:26
    ds_read2st64_b32 v[54:55], v17 offset0:27 offset1:28
    s_waitcnt lgkmcnt(0)
    v_pk_add_f32 v[48:49], v[48:49], v[50:51]
    v_pk_add_f32 v[52:53], v[52:53], v[54:55]
    v_pk_add_f32 v[48:49], v[48:49], v[52:53]
    v_add_f32 v48, v48, v49
    v_cvt_pk_bf16_f32 v48, 0, v48
    v_mov_b32 v49, v48
    s_nop 1
    v_permlane32_swap_b32 v48, v49
    v_mul_f32 v48, s57, v48
    v_max_f32 v48, 0xc2fc0000, v48
    v_exp_f32 v48, -v48
    s_nop 0
    v_add_f32 v48, 1.0, v48
    v_rcp_f32 v50, v48
    s_nop 0
    v_fma_f32 v48, -v48, v50, 1.0
    v_fma_f32 v48, v48, v50, v50
    v_cvt_pk_bf16_f32 v48, 0, v48
    v_mul_f32 v48, v48, v49
    v_cvt_pk_bf16_f32 v48, 0, v48
    ds_write_b16_d16_hi v10, v48
    ds_read_b128 v[20:23], v11
    s_waitcnt lgkmcnt(0)
    v_mfma_f32_16x16x32_bf16 v[48:51], v[20:23], v[32:35], 0
    v_mfma_f32_16x16x32_bf16 v[52:55], v[20:23], v[36:39], 0
    v_mfma_f32_16x16x32_bf16 v[56:59], v[20:23], v[40:43], 0
    v_mfma_f32_16x16x32_bf16 v[60:63], v[20:23], v[44:47], 0
    s_mov_b64 exec, 0xffff
    s_nop 3
    v_and_or_b32 v28, v48, s46, v2
    v_and_or_b32 v29, v52, s46, v2
    v_and_or_b32 v30, v56, s46, v2
    v_and_or_b32 v31, v60, s46, v2
    buffer_store_dwordx4 v[28:31], v12, s[8:11], s62 offen sc1
    s_add_u32 s42, s62, 8192
    buffer_store_dwordx4 v[28:31], v12, s[8:11], s42 offen sc1
    s_waitcnt vmcnt(0)
    s_barrier
    s_endpgm
L_R:
    s_and_b32 s42, s4, 1
    s_cselect_b32 s40, 7, 1
    s_cselect_b32 s41, 0, 256
    s_sub_u32 s40, s59, s40
    s_lshl_b32 s40, s40, 6
    s_and_b32 s40, s40, 0xffffff80
    s_and_b32 s42, s3, 3
    s_lshl_b32 s42, s42, 6
    s_add_u32 s41, s41, s42
    s_mul_i32 s41, s41, 3584
    s_add_u32 s40, s40, s41
    v_mul_u32_u24 v5, 3584, v1
    s_barrier
    s_cmp_ge_u32 s3, 4
    s_cbranch_scc1 L_R_up
    buffer_load_dword v8, v5, s[28:31], s40 offen
    s_branch L_R_done
L_R_up:
    buffer_load_dword v8, v5, s[32:35], s40 offen
L_R_done:
    s_waitcnt vmcnt(0)
    s_endpgm
P_13_t:
    s_waitcnt vmcnt(0)
    s_branch P_13_x
P_14_t:
    s_waitcnt vmcnt(0)
    s_branch P_14_x
L_M_comm:
    s_load_dwordx2 s[64:65], s[0:1], 88
    s_mov_b32 s66, 0x400
    s_mov_b32 s67, 0x20000
    s_and_b32 s58, s5, 7
    v_mov_b32 v14, 1152
    v_mov_b32 v15, 0
    ds_write_b32 v14, v15
    s_waitcnt lgkmcnt(0)
    s_load_dword s45, s[8:9], 0
    s_mov_b32 s46, 0xfffffc00
    s_mov_b32 s50, 0x05040100
    s_mov_b32 s51, 0x07060302
    s_waitcnt lgkmcnt(0)
    s_add_u32 s45, s45, 1
    s_and_b32 s6, s45, 1023
    v_mov_b32 v2, s6
    s_getreg_b32 s44, hwreg(HW_REG_XCC_ID)
    s_and_b32 s44, s44, 0xffff
    s_lshl_b32 s44, s44, 16
    s_or_b32 s44, s44, s6
    v_mov_b32 v4, s44
    v_mov_b32 v5, s44
    v_mov_b32 v6, s44
    v_mov_b32 v7, s44
    v_mov_b32 v8, 0
    s_lshl_b32 s48, s4, 8
    s_add_u32 s48, s48, 1024
    s_and_b32 s49, s5, 15
    s_lshl_b32 s49, s49, 17
    s_add_u32 s49, s49, s48
    s_lshr_b32 s42, s5, 4
    s_lshl_b32 s42, s42, 7
    s_add_u32 s49, s49, s42
    s_mov_b64 exec, 1
    buffer_store_dwordx4 v[4:7], v8, s[8:11], s49 offen sc1
    s_mov_b64 exec, -1
    v_and_b32 v3, 15, v1
    v_lshlrev_b32 v3, 17, v3
    v_bfe_u32 v8, v1, 4, 1
    v_lshl_add_u32 v3, v8, 7, v3
    v_lshlrev_b32 v22, 6, v1
    s_lshl_b32 s42, s4, 3
    s_add_u32 s42, s42, s58
    s_lshl_b32 s42, s42, 12
    s_add_u32 s42, s42, 2359296
    buffer_load_dword v108, v22, s[8:11], s42 offen sc1
    v_and_b32 v9, 7, v1
    v_lshlrev_b32 v9, 8, v9
    s_lshl_b32 s40, s58, 18
    s_add_u32 s40, s40, 32768
    s_mov_b32 s47, 0
P_15:
    buffer_load_dwordx2 v[32:33], v9, s[8:11], s40 offen sc1
    s_add_u32 s47, s47, 1
    s_cmp_gt_u32 s47, 1000000
    s_cbranch_scc1 P_15_t
    s_waitcnt vmcnt(0)
    v_xor_b32 v30, s45, v33
    v_cmp_ne_u32 vcc, 0, v30
    s_cbranch_vccz P_15_x
    s_sleep 2
    s_branch P_15
P_15_x:
    s_barrier
    s_cmp_eq_u32 s58, 7
    s_cbranch_scc1 L_M_cdone
    s_and_b32 s42, s5, 15
    s_lshl_b32 s42, s42, 17
    s_lshl_b32 s43, s4, 10
    s_add_u32 s42, s42, s43
    s_add_u32 s42, s42, 65536
    s_add_u32 s78, s8, s42
    s_addc_u32 s79, s9, 0
    s_mov_b32 s76, -1
    s_mov_b32 s77, -1
    s_load_dword s42, s[78:79], 0 glc
    s_load_dword s43, s[78:79], 8192 glc
    s_waitcnt lgkmcnt(0)
    s_memtime s[72:73]
    s_waitcnt lgkmcnt(0)
    s_load_dword s42, s[78:79], 0 glc
    s_waitcnt lgkmcnt(0)
    s_memtime s[74:75]
    s_waitcnt lgkmcnt(0)
    s_sub_u32 s74, s74, s72
    s_min_u32 s76, s76, s74
    s_memtime s[72:73]
    s_waitcnt lgkmcnt(0)
    s_load_dword s42, s[78:79], 8192 glc
    s_waitcnt lgkmcnt(0)
    s_memtime s[74:75]
    s_waitcnt lgkmcnt(0)
    s_sub_u32 s74, s74, s72
    s_min_u32 s77, s77, s74
    s_memtime s[72:73]
    s_waitcnt lgkmcnt(0)
    s_load_dword s42, s[78:79], 0 glc
    s_waitcnt lgkmcnt(0)
    s_memtime s[74:75]
    s_waitcnt lgkmcnt(0)
    s_sub_u32 s74, s74, s72
    s_min_u32 s76, s76, s74
    s_memtime s[72:73]
    s_waitcnt lgkmcnt(0)
    s_load_dword s42, s[78:79], 8192 glc
    s_waitcnt lgkmcnt(0)
    s_memtime s[74:75]
    s_waitcnt lgkmcnt(0)
    s_sub_u32 s74, s74, s72
    s_min_u32 s77, s77, s74
    s_memtime s[72:73]
    s_waitcnt lgkmcnt(0)
    s_load_dword s42, s[78:79], 0 glc
    s_waitcnt lgkmcnt(0)
    s_memtime s[74:75]
    s_waitcnt lgkmcnt(0)
    s_sub_u32 s74, s74, s72
    s_min_u32 s76, s76, s74
    s_memtime s[72:73]
    s_waitcnt lgkmcnt(0)
    s_load_dword s42, s[78:79], 8192 glc
    s_waitcnt lgkmcnt(0)
    s_memtime s[74:75]
    s_waitcnt lgkmcnt(0)
    s_sub_u32 s74, s74, s72
    s_min_u32 s77, s77, s74
    s_memtime s[72:73]
    s_waitcnt lgkmcnt(0)
    s_load_dword s42, s[78:79], 0 glc
    s_waitcnt lgkmcnt(0)
    s_memtime s[74:75]
    s_waitcnt lgkmcnt(0)
    s_sub_u32 s74, s74, s72
    s_min_u32 s76, s76, s74
    s_memtime s[72:73]
    s_waitcnt lgkmcnt(0)
    s_load_dword s42, s[78:79], 8192 glc
    s_waitcnt lgkmcnt(0)
    s_memtime s[74:75]
    s_waitcnt lgkmcnt(0)
    s_sub_u32 s74, s74, s72
    s_min_u32 s77, s77, s74
    s_cmp_lt_u32 s77, s76
    s_cselect_b32 s76, 8192, 0
    v_mov_b32 v15, s76
    ds_write_b32 v14, v15
    s_cmp_ge_u32 s58, 2
    s_cbranch_scc1 L_M_cdone
    s_lshl_b32 s59, s4, 1
    s_add_u32 s59, s59, s58
    v_and_b32 v10, 31, v1
    v_lshlrev_b32 v11, 1, v10
    v_lshlrev_b32 v12, 2, v10
    v_lshlrev_b32 v17, 2, v1
    s_lshl_b32 s40, s59, 6
    s_lshl_b32 s42, s59, 7
    v_add_u32 v13, s42, v12
    s_lshl_b32 s54, s59, 9
    s_add_u32 s54, s54, 16384
    s_add_u32 s54, s54, s76
    s_mul_i32 s41, s4, 12288
    s_add_u32 s41, s41, s42
    s_add_u32 s41, s41, 2123776
    v_add_u32 v65, 131072, v17
    v_add_u32 v66, 262144, v17
    v_add_u32 v67, 393216, v17
    v_add_u32 v68, 524288, v17
    v_add_u32 v69, 655360, v17
    v_add_u32 v70, 786432, v17
    v_add_u32 v71, 917504, v17
    v_add_u32 v72, 1048576, v17
    v_add_u32 v73, 1179648, v17
    v_add_u32 v74, 1310720, v17
    v_add_u32 v75, 1441792, v17
    v_add_u32 v76, 1572864, v17
    v_add_u32 v77, 1703936, v17
    v_add_u32 v78, 1835008, v17
    v_add_u32 v79, 1966080, v17
    v_mov_b32 v64, v17
    s_barrier
    ds_read_b32 v28, v13 offset:2048
    s_waitcnt lgkmcnt(0)
    s_barrier
    s_mov_b32 s47, 0
P_16:
    buffer_load_dword v29, v12, s[8:11], s41 offen sc1
    buffer_load_dword v31, v12, s[8:11], s41 offen sc1
    s_add_u32 s47, s47, 1
    s_cmp_gt_u32 s47, 1000000
    s_cbranch_scc1 P_16_t
    s_waitcnt vmcnt(0)
    v_xor_b32 v29, v2, v29
    v_xor_b32 v31, v2, v31
    v_or_b32 v30, v29, v31
    v_and_b32 v30, 1023, v30
    v_cmp_ne_u32 vcc, 0, v30
    s_cbranch_vccnz P_16
P_16_x:
    s_barrier
    s_mov_b32 s47, 0
P_17:
    buffer_load_dword v32, v64, s[8:11], s54 offen offset:0 sc1
    buffer_load_dword v33, v65, s[8:11], s54 offen offset:0 sc1
    buffer_load_dword v34, v66, s[8:11], s54 offen offset:0 sc1
    buffer_load_dword v35, v67, s[8:11], s54 offen offset:0 sc1
    buffer_load_dword v36, v68, s[8:11], s54 offen offset:0 sc1
    buffer_load_dword v37, v69, s[8:11], s54 offen offset:0 sc1
    buffer_load_dword v38, v70, s[8:11], s54 offen offset:0 sc1
    buffer_load_dword v39, v71, s[8:11], s54 offen offset:0 sc1
    buffer_load_dword v40, v72, s[8:11], s54 offen offset:0 sc1
    buffer_load_dword v41, v73, s[8:11], s54 offen offset:0 sc1
    buffer_load_dword v42, v74, s[8:11], s54 offen offset:0 sc1
    buffer_load_dword v43, v75, s[8:11], s54 offen offset:0 sc1
    buffer_load_dword v44, v76, s[8:11], s54 offen offset:0 sc1
    buffer_load_dword v45, v77, s[8:11], s54 offen offset:0 sc1
    buffer_load_dword v46, v78, s[8:11], s54 offen offset:0 sc1
    buffer_load_dword v47, v79, s[8:11], s54 offen offset:0 sc1
    buffer_load_dword v48, v64, s[8:11], s54 offen offset:256 sc1
    buffer_load_dword v49, v65, s[8:11], s54 offen offset:256 sc1
    buffer_load_dword v50, v66, s[8:11], s54 offen offset:256 sc1
    buffer_load_dword v51, v67, s[8:11], s54 offen offset:256 sc1
    buffer_load_dword v52, v68, s[8:11], s54 offen offset:256 sc1
    buffer_load_dword v53, v69, s[8:11], s54 offen offset:256 sc1
    buffer_load_dword v54, v70, s[8:11], s54 offen offset:256 sc1
    buffer_load_dword v55, v71, s[8:11], s54 offen offset:256 sc1
    buffer_load_dword v56, v72, s[8:11], s54 offen offset:256 sc1
    buffer_load_dword v57, v73, s[8:11], s54 offen offset:256 sc1
    buffer_load_dword v58, v74, s[8:11], s54 offen offset:256 sc1
    buffer_load_dword v59, v75, s[8:11], s54 offen offset:256 sc1
    s_add_u32 s47, s47, 1
    s_cmp_gt_u32 s47, 1000000
    s_cbranch_scc1 P_17_t
    s_waitcnt vmcnt(24)
    v_xor_b32 v32, v2, v32
    v_xor_b32 v33, v2, v33
    v_xor_b32 v34, v2, v34
    v_xor_b32 v35, v2, v35
    v_or_b32 v30, v32, v33
    v_pk_add_f32 v[60:61], v[32:33], v[34:35]
    v_or3_b32 v30, v30, v34, v35
    s_waitcnt vmcnt(20)
    v_xor_b32 v36, v2, v36
    v_xor_b32 v37, v2, v37
    v_xor_b32 v38, v2, v38
    v_xor_b32 v39, v2, v39
    v_or3_b32 v30, v30, v36, v37
    v_or3_b32 v30, v30, v38, v39
    v_pk_add_f32 v[36:37], v[36:37], v[38:39]
    v_pk_add_f32 v[60:61], v[60:61], v[36:37]
    s_waitcnt vmcnt(16)
    v_xor_b32 v40, v2, v40
    v_xor_b32 v41, v2, v41
    v_xor_b32 v42, v2, v42
    v_xor_b32 v43, v2, v43
    v_or3_b32 v30, v30, v40, v41
    v_or3_b32 v30, v30, v42, v43
    v_pk_add_f32 v[40:41], v[40:41], v[42:43]
    v_pk_add_f32 v[60:61], v[60:61], v[40:41]
    s_waitcnt vmcnt(12)
    v_xor_b32 v44, v2, v44
    v_xor_b32 v45, v2, v45
    v_xor_b32 v46, v2, v46
    v_xor_b32 v47, v2, v47
    v_or3_b32 v30, v30, v44, v45
    v_or3_b32 v30, v30, v46, v47
    v_pk_add_f32 v[44:45], v[44:45], v[46:47]
    v_pk_add_f32 v[60:61], v[60:61], v[44:45]
    s_waitcnt vmcnt(8)
    v_xor_b32 v48, v2, v48
    v_xor_b32 v49, v2, v49
    v_xor_b32 v50, v2, v50
    v_xor_b32 v51, v2, v51
    v_or3_b32 v30, v30, v48, v49
    v_or3_b32 v30, v30, v50, v51
    v_pk_add_f32 v[48:49], v[48:49], v[50:51]
    v_pk_add_f32 v[60:61], v[60:61], v[48:49]
    s_waitcnt vmcnt(4)
    v_xor_b32 v52, v2, v52
    v_xor_b32 v53, v2, v53
    v_xor_b32 v54, v2, v54
    v_xor_b32 v55, v2, v55
    v_or3_b32 v30, v30, v52, v53
    v_or3_b32 v30, v30, v54, v55
    v_pk_add_f32 v[52:53], v[52:53], v[54:55]
    v_pk_add_f32 v[60:61], v[60:61], v[52:53]
    s_waitcnt vmcnt(0)
    v_xor_b32 v56, v2, v56
    v_xor_b32 v57, v2, v57
    v_xor_b32 v58, v2, v58
    v_xor_b32 v59, v2, v59
    v_or3_b32 v30, v30, v56, v57
    v_or3_b32 v30, v30, v58, v59
    v_and_b32 v30, 1023, v30
    v_cmp_ne_u32 vcc, 0, v30
    v_pk_add_f32 v[56:57], v[56:57], v[58:59]
    v_pk_add_f32 v[60:61], v[60:61], v[56:57]
    s_cbranch_vccnz P_17
P_17_x:
    v_add_f32 v32, v60, v61
    v_mov_b32 v33, v32
    s_nop 1
    v_permlane32_swap_b32 v32, v33
    v_add_f32 v32, v32, v33
    v_cvt_pk_bf16_f32 v32, 0, v32
    v_mul_f32 v32, v29, v32
    v_cvt_pk_bf16_f32 v32, 0, v32
    v_add_f32 v32, v28, v32
    v_cvt_pk_bf16_f32 v32, 0, v32
    s_mov_b32 exec_hi, 0
    buffer_store_short_d16_hi v32, v11, s[64:67], s40 offen sc1
    s_cmp_lg_u32 s59, 0
    s_cbranch_scc1 L_M_noep
    s_mov_b64 exec, 1
    v_mov_b32 v33, s45
    v_mov_b32 v34, 0
    buffer_store_dword v33, v34, s[8:11], 0 offen sc1
L_M_noep:
L_M_cdone:
    s_endpgm
P_15_t:
    s_waitcnt vmcnt(0)
    s_branch P_15_x
P_16_t:
    s_waitcnt vmcnt(0)
    s_branch P_16_x
P_17_t:
    s_waitcnt vmcnt(0)
    s_branch P_17_x
L_exit:
    s_endpgm
L_code_end:
.section .rodata,"a"
.p2align 6
.amdhsa_kernel adaLN_cond__sliding_block_cached__glu_gated_glu__decode_kernel
  .amdhsa_next_free_vgpr 128
  .amdhsa_next_free_sgpr 100
  .amdhsa_accum_offset 128
  .amdhsa_group_segment_fixed_size 0
  .amdhsa_kernarg_size 112
  .amdhsa_user_sgpr_count 2
  .amdhsa_user_sgpr_kernarg_segment_ptr 1
  .amdhsa_system_sgpr_workgroup_id_x 1
.end_amdhsa_kernel
```
